```python
import torch

def _softmax(x, axis=-1):
    return torch.softmax(x, dim=axis)
def _gelu(x):
    return torch.nn.functional.gelu(x, approximate="tanh")
def _silu(x):
    return torch.nn.functional.silu(x)
def _sigmoid(x):
    return torch.sigmoid(x)
def _layernorm(x, axis=-1, eps=1e-5):
    m = x.mean(dim=axis, keepdim=True)
    v = x.var(dim=axis, keepdim=True, unbiased=False)
    return (x - m) / torch.sqrt(v + eps)
def _scatter_add(tgt, idx, src, axis=0):
    return tgt.clone().index_add_(axis, idx, src)
def _segment_sum(src, seg, n):
    out = torch.zeros((n,) + src.shape[1:], dtype=src.dtype)
    return out.index_add_(0, seg, src)
def _pad(x, pw):
    flat = tuple(v for pair in reversed(pw) for v in pair)
    return torch.nn.functional.pad(x, flat)

kernel_name = 'concat_heads__mha_block_cached__mha_block_cached__decode'

def setup_inputs():

    _w = (lambda a: (lambda t: t.to(torch.bfloat16) if t.is_floating_point() else t)(torch.as_tensor(a)))
    def _A_setup():
        B, Sq, D = 2, 1, 448
        H, Sk, Dh = 16, 4096, 256
        return {
            "x": _w((lambda *s: torch.randn(*s, dtype=torch.bfloat16) * 0.8)(B, Sq, D)),
            "k_cache": _w((lambda *s: torch.randn(*s, dtype=torch.bfloat16) * 0.8)(B, H, Sk, Dh)),
            "v_cache": _w((lambda *s: torch.randn(*s, dtype=torch.bfloat16) * 0.05)(B, H, Sk, Dh)),
            "wq": _w((lambda *s: torch.randn(*s, dtype=torch.bfloat16) * 0.8)(D, H * Dh) * (D ** -0.5)),
            "wo": _w((lambda *s: torch.randn(*s, dtype=torch.bfloat16) * 0.05)(H * Dh, D) * ((H * Dh) ** -0.5)),
        }
    _A_in = _A_setup()

    def _B_setup():
        B, Sq, D = 2, 1, 448
        H, Sk, Dh = 16, 4096, 256
        return {
            "x": _w((lambda *s: torch.randn(*s, dtype=torch.bfloat16) * 0.8)(B, Sq, D)),
            "k_cache": _w((lambda *s: torch.randn(*s, dtype=torch.bfloat16) * 0.8)(B, H, Sk, Dh)),
            "v_cache": _w((lambda *s: torch.randn(*s, dtype=torch.bfloat16) * 0.05)(B, H, Sk, Dh)),
            "wq": _w((lambda *s: torch.randn(*s, dtype=torch.bfloat16) * 0.8)(D, H * Dh) * (D ** -0.5)),
            "wo": _w((lambda *s: torch.randn(*s, dtype=torch.bfloat16) * 0.05)(H * Dh, D) * ((H * Dh) ** -0.5)),
        }
    _B_in = _B_setup()

    return {
        "A_x": _A_in["x"],
        "A_k_cache": _A_in["k_cache"],
        "A_v_cache": _A_in["v_cache"],
        "A_wq": _A_in["wq"],
        "A_wo": _A_in["wo"],
        "B_x": _B_in["x"],
        "B_k_cache": _B_in["k_cache"],
        "B_v_cache": _B_in["v_cache"],
        "B_wq": _B_in["wq"],
        "B_wo": _B_in["wo"],
    }

def reference(A_x, A_k_cache, A_v_cache, A_wq, A_wo, B_x, B_k_cache, B_v_cache, B_wq, B_wo):
    def _A_ref(x, k_cache, v_cache, wq, wo):
        B, Sq, D = x.shape
        H, Dh = 16, 256
        q = (lambda x, *d: x.permute(*d))((x @ wq).reshape(B, Sq, H, Dh), 0, 2, 1, 3)
        scores = torch.einsum("bhqd,bhkd->bhqk", q, k_cache) * (Dh ** -0.5)
        p = _softmax(scores, axis=-1)
        o = torch.einsum("bhqk,bhkd->bhqd", p, v_cache)
        return (lambda x, *d: x.permute(*d))(o, 0, 2, 1, 3).reshape(B, Sq, H * Dh) @ wo

    def _B_ref(x, k_cache, v_cache, wq, wo):
        B, Sq, D = x.shape
        H, Dh = 16, 256
        q = (lambda x, *d: x.permute(*d))((x @ wq).reshape(B, Sq, H, Dh), 0, 2, 1, 3)
        scores = torch.einsum("bhqd,bhkd->bhqk", q, k_cache) * (Dh ** -0.5)
        p = _softmax(scores, axis=-1)
        o = torch.einsum("bhqk,bhkd->bhqd", p, v_cache)
        return (lambda x, *d: x.permute(*d))(o, 0, 2, 1, 3).reshape(B, Sq, H * Dh) @ wo

    a = _A_ref(A_x, A_k_cache, A_v_cache, A_wq, A_wo)
    b = _B_ref(B_x, B_k_cache, B_v_cache, B_wq, B_wo)
    return torch.concatenate([a, b], axis=-1)
```

```asm
; @launch grid=(256,1,1) block=(256,1,1) lds=163840
.amdgcn_target "amdgcn-amd-amdhsa--gfx950"
.text
.globl concat_heads__mha_block_cached__mha_block_cached__decode_kernel
.p2align 12
.p2align 8
.type concat_heads__mha_block_cached__mha_block_cached__decode_kernel,@function
concat_heads__mha_block_cached__mha_block_cached__decode_kernel:
    s_cmp_ge_u32 s2, 256
    s_cbranch_scc1 L_end0
    s_load_dwordx16 s[8:23], s[0:1], 0
    s_load_dwordx8 s[24:31], s[0:1], 64
    s_load_dwordx2 s[32:33], s[0:1], 96
    v_lshrrev_b32 v44, 6, v0
    v_and_b32 v1, 63, v0
    v_readfirstlane_b32 s3, v44
    s_and_b32 s4, s2, 7
    s_lshl_b32 s4, s4, 1
    s_lshr_b32 s5, s2, 7
    s_add_u32 s4, s4, s5
    s_bfe_u32 s5, s2, 0x10006
    s_bfe_u32 s6, s2, 0x30003
    v_lshlrev_b32 v2, 4, v1
    s_cmp_eq_u32 s3, 0
    s_cbranch_scc1 L_helper
    s_sub_u32 s3, s3, 1
    s_mul_i32 s35, s4, 3
    s_mul_i32 s7, s5, 4
    s_add_u32 s35, s35, s7
    s_lshl_b32 s35, s35, 1
    s_lshl_b32 s34, s5, 4
    s_add_u32 s34, s34, s4
    s_lshl_b32 s34, s34, 21
    s_lshl_b32 s7, s6, 14
    s_add_u32 s34, s34, s7
    s_add_u32 s90, s3, s35
    s_and_b32 s92, s90, 31
    s_and_b32 s7, s90, 1
    s_lshr_b32 s90, s92, 1
    s_lshl_b32 s90, s90, 17
    s_lshl_b32 s7, s7, 13
    s_add_u32 s90, s90, s34
    s_add_u32 s90, s90, s7
    s_add_u32 s91, s90, 4096
    s_lshl_b32 s93, s3, 13
    s_add_u32 m0, s93, 8192
    s_add_u32 s93, s93, 12288
    s_brev_b32 s71, 1
    s_mov_b32 s66, 0x4000000
    s_mov_b32 s67, 0x20000
    s_waitcnt lgkmcnt(0)
    s_mov_b64 s[64:65], s[10:11]
    buffer_load_dwordx4 v2, s[64:67], s90 offen offset:0 nt lds
    buffer_load_dwordx4 v2, s[64:67], s90 offen offset:1024 nt lds
    buffer_load_dwordx4 v2, s[64:67], s90 offen offset:2048 nt lds
    buffer_load_dwordx4 v2, s[64:67], s90 offen offset:3072 nt lds
    s_mov_b32 m0, s93
    s_bitset1_b32 s71, s3
    buffer_load_dwordx4 v2, s[64:67], s91 offen offset:0 nt lds
    buffer_load_dwordx4 v2, s[64:67], s91 offen offset:1024 nt lds
    buffer_load_dwordx4 v2, s[64:67], s91 offen offset:2048 nt lds
    buffer_load_dwordx4 v2, s[64:67], s91 offen offset:3072 nt lds
    s_mov_b32 s92, 4096
L_tret:
    s_mov_b64 s[80:81], s[32:33]
    s_mov_b32 s82, 4325376
    s_mov_b32 s83, 0x20000
    s_bitcmp1_b32 s6, 2
    s_cselect_b64 s[76:77], s[26:27], s[16:17]
    s_mov_b32 s78, 3670016
    s_mov_b32 s79, 0x20000
    s_mov_b64 s[84:85], s[28:29]
    s_mov_b32 s86, 3584
    s_mov_b32 s87, 0x20000
    v_and_b32 v11, 32, v1
    v_bfe_u32 v44, v1, 2, 1
    v_lshl_add_u32 v10, v44, 4, v11
    v_and_b32 v44, 8, v1
    v_add_u32 v10, v44, v10
    v_bfe_u32 v44, v1, 4, 1
    v_lshl_add_u32 v10, v44, 2, v10
    v_and_b32 v53, 31, v1
    v_lshlrev_b32 v53, 4, v53
    v_mov_b32 v56, 1024
    v_mov_b32 v58, 1
    s_mov_b32 s70, 1
    s_mov_b32 s38, 32
    s_mul_i32 s89, s3, 8
    s_mov_b32 s39, 0x400000
    s_barrier
L_K0:
    v_add_u32 v52, s92, v10
    s_waitcnt vmcnt(4)
    s_mov_b64 exec, 1
    ds_add_rtn_u32 v59, v56, v58
    s_mov_b64 exec, -1
    v_dot2_f32_bf16 v44, v64, v6, 0
    v_dot2_f32_bf16 v45, v68, v6, 0
    v_dot2_f32_bf16 v46, v72, v6, 0
    v_dot2_f32_bf16 v47, v76, v6, 0
    v_dot2_f32_bf16 v44, v65, v7, v44
    v_dot2_f32_bf16 v45, v69, v7, v45
    v_dot2_f32_bf16 v46, v73, v7, v46
    v_dot2_f32_bf16 v47, v77, v7, v47
    v_dot2_f32_bf16 v44, v66, v8, v44
    v_dot2_f32_bf16 v45, v70, v8, v45
    v_dot2_f32_bf16 v46, v74, v8, v46
    v_dot2_f32_bf16 v47, v78, v8, v47
    v_dot2_f32_bf16 v44, v67, v9, v44
    v_dot2_f32_bf16 v45, v71, v9, v45
    v_dot2_f32_bf16 v46, v75, v9, v46
    v_dot2_f32_bf16 v47, v79, v9, v47
    s_waitcnt vmcnt(0)
    v_dot2_f32_bf16 v48, v80, v6, 0
    v_dot2_f32_bf16 v49, v84, v6, 0
    v_dot2_f32_bf16 v50, v88, v6, 0
    v_dot2_f32_bf16 v51, v92, v6, 0
    v_dot2_f32_bf16 v48, v81, v7, v48
    v_dot2_f32_bf16 v49, v85, v7, v49
    v_dot2_f32_bf16 v50, v89, v7, v50
    v_dot2_f32_bf16 v51, v93, v7, v51
    v_dot2_f32_bf16 v48, v82, v8, v48
    v_dot2_f32_bf16 v49, v86, v8, v49
    v_dot2_f32_bf16 v50, v90, v8, v50
    v_dot2_f32_bf16 v51, v94, v8, v51
    v_dot2_f32_bf16 v48, v83, v9, v48
    v_dot2_f32_bf16 v49, v87, v9, v49
    v_dot2_f32_bf16 v50, v91, v9, v50
    v_dot2_f32_bf16 v51, v95, v9, v51
    s_waitcnt lgkmcnt(0)
    v_readfirstlane_b32 s36, v59
    s_bitcmp1_b32 s36, 5
    s_cselect_b64 s[64:65], s[20:21], s[10:11]
    s_cselect_b64 s[68:69], s[22:23], s[12:13]
    s_bitcmp1_b32 s36, 6
    s_cselect_b64 s[64:65], s[68:69], s[64:65]
    s_and_b32 s37, s36, 0xff
    s_add_u32 s90, s36, s35
    s_and_b32 s92, s90, 31
    s_and_b32 s7, s90, 1
    s_lshr_b32 s90, s92, 1
    s_lshl_b32 s90, s90, 17
    s_lshl_b32 s7, s7, 13
    s_add_u32 s90, s90, s34
    s_add_u32 s90, s90, s7
    s_add_u32 s91, s90, 4096
    s_lshl_b32 s92, s92, 6
    s_cmp_lt_u32 s36, 19
    s_cbranch_scc1 L_park
    buffer_load_dwordx4 v[64:67], v2, s[64:67], s90 offen offset:0 nt
    buffer_load_dwordx4 v[68:71], v2, s[64:67], s90 offen offset:1024 nt
    buffer_load_dwordx4 v[72:75], v2, s[64:67], s90 offen offset:2048 nt
    buffer_load_dwordx4 v[76:79], v2, s[64:67], s90 offen offset:3072 nt
    buffer_load_dwordx4 v[80:83], v2, s[64:67], s91 offen offset:0 nt
    buffer_load_dwordx4 v[84:87], v2, s[64:67], s91 offen offset:1024 nt
    buffer_load_dwordx4 v[88:91], v2, s[64:67], s91 offen offset:2048 nt
    buffer_load_dwordx4 v[92:95], v2, s[64:67], s91 offen offset:3072 nt
L_K0t:
    v_permlane16_swap_b32 v44, v45
    v_permlane16_swap_b32 v46, v47
    v_permlane16_swap_b32 v48, v49
    v_permlane16_swap_b32 v50, v51
    v_add_f32 v44, v44, v45
    v_add_f32 v46, v46, v47
    v_add_f32 v48, v48, v49
    v_add_f32 v50, v50, v51
    v_add_f32_dpp v45, v44, v44 row_ror:8 row_mask:0xf bank_mask:0x3
    v_add_f32_dpp v47, v48, v48 row_ror:8 row_mask:0xf bank_mask:0x3
    s_nop 0
    v_add_f32_dpp v45, v46, v46 row_ror:8 row_mask:0xf bank_mask:0xc
    v_add_f32_dpp v47, v50, v50 row_ror:8 row_mask:0xf bank_mask:0xc
    s_nop 0
    v_add_f32_dpp v44, v45, v45 row_half_mirror row_mask:0xf bank_mask:0x5
    s_nop 1
    v_add_f32_dpp v44, v47, v47 row_half_mirror row_mask:0xf bank_mask:0xa
    s_nop 1
    v_add_f32_dpp v44, v44, v44 quad_perm:[1,0,3,2] row_mask:0xf bank_mask:0xf
    s_nop 1
    v_add_f32_dpp v44, v44, v44 quad_perm:[2,3,0,1] row_mask:0xf bank_mask:0xf
    ds_write_b32 v52, v44 offset:2048
L_K0c:
    s_cmp_lg_u32 s71, 0
    s_cbranch_scc1 L_slow
    s_cmp_ge_u32 s37, s38
    s_cbranch_scc1 L_T01
    s_lshr_b32 s63, s36, 24
    s_sub_i32 s63, s63, s89
    s_cmp_ge_i32 s37, s63
    s_cbranch_scc1 L_K0
    s_branch L_K0B
L_park:
    s_lshl_b32 s93, s36, 13
    s_add_u32 m0, s93, 8192
    s_add_u32 s93, s93, 12288
    buffer_load_dwordx4 v2, s[64:67], s90 offen offset:0 nt lds
    buffer_load_dwordx4 v2, s[64:67], s90 offen offset:1024 nt lds
    buffer_load_dwordx4 v2, s[64:67], s90 offen offset:2048 nt lds
    buffer_load_dwordx4 v2, s[64:67], s90 offen offset:3072 nt lds
    s_mov_b32 m0, s93
    s_bitset1_b32 s71, s36
    buffer_load_dwordx4 v2, s[64:67], s91 offen offset:0 nt lds
    buffer_load_dwordx4 v2, s[64:67], s91 offen offset:1024 nt lds
    buffer_load_dwordx4 v2, s[64:67], s91 offen offset:2048 nt lds
    buffer_load_dwordx4 v2, s[64:67], s91 offen offset:3072 nt lds
    s_mov_b32 s92, 4096
    s_branch L_K0t
L_slow:
    s_bitcmp0_b32 s71, 31
    s_cbranch_scc1 L_drain
    s_cmp_eq_u32 s92, 4096
    s_cbranch_scc1 L_fillc
    s_mov_b32 s63, s36
L_spin:
    s_bitcmp1_b32 s63, 17
    s_cbranch_scc1 L_spinx
    ds_read_b32 v59, v56
    s_sub_u32 s39, s39, 1
    s_waitcnt lgkmcnt(0)
    v_readfirstlane_b32 s63, v59
    s_cmp_gt_i32 s39, 0
    s_cbranch_scc1 L_spin
L_spinx:
    ds_read_b128 v[6:9], v53 offset:0
    s_bitset0_b32 s71, 31
    s_waitcnt lgkmcnt(0)
    s_branch L_K0c
L_fillc:
    s_cmp_eq_u32 s70, 0
    s_cbranch_scc1 L_K0
    s_mov_b32 s93, 4096
    s_branch L_K0Y
L_end0:
    s_endpgm
L_helper:
    s_setprio 3
    s_mov_b32 s3, 3
    v_lshrrev_b32 v44, 4, v1
    v_and_b32 v3, 15, v1
    v_mul_u32_u24 v4, 114688, v44
    v_lshl_add_u32 v4, v3, 4, v4
    v_lshrrev_b32 v46, 3, v3
    v_mul_u32_u24 v46, 896, v46
    v_mul_u32_u24 v45, 28, v44
    v_add_u32 v5, v46, v45
    s_bfe_u32 s35, s2, 0x30004
    s_bfe_u32 s36, s2, 0x10003
    s_mul_i32 s90, s35, 458752
    s_lshl_b32 s37, s4, 9
    s_add_u32 s90, s90, s37
    s_lshl_b32 s37, s36, 8
    s_add_u32 s90, s90, s37
    s_mul_i32 s96, s35, 112
    s_mov_b32 s74, 3670016
    s_mov_b32 s75, 0x20000
    s_mov_b32 s66, 1792
    s_mov_b32 s67, 0x20000
    s_mov_b32 s70, 1792
    s_mov_b32 s71, 0x20000
    s_movk_i32 s91, 0x2000
    s_waitcnt lgkmcnt(0)
    s_mov_b64 s[72:73], s[14:15]
    s_mov_b64 s[64:65], s[8:9]
    s_mov_b64 s[68:69], s[18:19]
    buffer_load_dwordx4 v[64:67], v4, s[72:75], s90 offen nt
    s_add_u32 s90, s90, s91
    buffer_load_dwordx4 v[68:71], v4, s[72:75], s90 offen nt
    s_add_u32 s90, s90, s91
    buffer_load_dwordx4 v[72:75], v4, s[72:75], s90 offen nt
    s_add_u32 s90, s90, s91
    buffer_load_dwordx4 v[76:79], v4, s[72:75], s90 offen nt
    s_add_u32 s90, s90, s91
    buffer_load_dwordx4 v[16:19], v5, s[64:67], s96 offen
    buffer_load_dwordx3 v[20:22], v5, s[64:67], s96 offen offset:16
    buffer_load_dwordx4 v[24:27], v5, s[68:71], s96 offen
    buffer_load_dwordx3 v[28:30], v5, s[68:71], s96 offen offset:16
    buffer_load_dwordx4 v[80:83], v4, s[72:75], s90 offen nt
    s_add_u32 s90, s90, s91
    buffer_load_dwordx4 v[84:87], v4, s[72:75], s90 offen nt
    s_add_u32 s90, s90, s91
    buffer_load_dwordx4 v[88:91], v4, s[72:75], s90 offen nt
    s_add_u32 s90, s90, s91
    buffer_load_dwordx4 v[92:95], v4, s[72:75], s90 offen nt
    s_add_u32 s90, s90, s91
    buffer_load_dwordx4 v[96:99], v4, s[72:75], s90 offen nt
    s_add_u32 s90, s90, s91
    buffer_load_dwordx4 v[100:103], v4, s[72:75], s90 offen nt
    s_add_u32 s90, s90, s91
    buffer_load_dwordx4 v[104:107], v4, s[72:75], s90 offen nt
    s_add_u32 s90, s90, s91
    buffer_load_dwordx4 v[108:111], v4, s[72:75], s90 offen nt
    s_add_u32 s90, s90, s91
    buffer_load_dwordx4 v[112:115], v4, s[72:75], s90 offen nt
    s_add_u32 s90, s90, s91
    buffer_load_dwordx4 v[116:119], v4, s[72:75], s90 offen nt
    s_add_u32 s90, s90, s91
    v_mov_b32 v56, 1024
    v_mov_b32 v36, 3
    v_mov_b32 v37, 0
    v_mov_b32 v38, 0
    v_mov_b32 v39, 0
    ds_write_b128 v56, v[36:39]
    v_mov_b32 v40, -1
    v_mov_b32 v41, -1
    v_mov_b32 v42, -1
    v_mov_b32 v43, -1
    ds_write_b128 v2, v[40:43] offset:2048
    ds_write_b128 v2, v[40:43] offset:3072
    ds_write_b128 v2, v[40:43] offset:4096
    ds_write_b128 v2, v[40:43] offset:5120
    s_waitcnt lgkmcnt(0)
    s_barrier
    s_load_dwordx2 s[94:95], s[32:33], 0
    s_mov_b64 s[80:81], s[32:33]
    s_mov_b32 s82, 4325376
    s_mov_b32 s83, 0x20000
    s_bitcmp1_b32 s6, 2
    s_cselect_b64 s[76:77], s[26:27], s[16:17]
    s_mov_b32 s78, 3670016
    s_mov_b32 s79, 0x20000
    s_mov_b64 s[84:85], s[28:29]
    s_mov_b32 s86, 3584
    s_mov_b32 s87, 0x20000
    s_getreg_b32 s88, hwreg(HW_REG_XCC_ID, 0, 4)
    v_mov_b32 v251, 0xfff
    v_mov_b32 v44, 0x40000000
    v_cmp_eq_u32 vcc, 0, v1
    s_nop 1
    v_cndmask_b32 v254, v44, v2, vcc
    s_mov_b32 s61, 0x100000
    v_and_b32 v46, 1, v1
    v_lshlrev_b32 v46, 4, v46
    v_mov_b32 v47, 0xffff
    v_lshlrev_b32 v47, v46, v47
    s_bfe_u32 s7, s2, 0x40003
    s_lshl_b32 s34, s4, 15
    s_add_u32 s34, s34, 65536
    s_lshl_b32 s39, s7, 10
    s_add_u32 s39, s39, s34
    s_add_u32 s38, s39, 0x4000
    s_lshl_b32 s63, s5, 7
    s_add_u32 s34, s34, s63
    v_bfe_u32 v44, v1, 1, 2
    v_mov_b32 v49, 0x0c0c0c0c
    v_mov_b32 v48, 0x01000100
    v_bfi_b32 v48, v47, v48, v49
    v_mov_b32 v50, 0x03020302
    v_bfi_b32 v50, v47, v50, v49
    v_cmp_eq_u32 vcc, 0, v44
    s_nop 1
    v_cndmask_b32 v8, v49, v48, vcc
    v_cndmask_b32 v12, v49, v50, vcc
    v_cmp_eq_u32 vcc, 1, v44
    s_nop 1
    v_cndmask_b32 v9, v49, v48, vcc
    v_cndmask_b32 v13, v49, v50, vcc
    v_cmp_eq_u32 vcc, 2, v44
    s_nop 1
    v_cndmask_b32 v10, v49, v48, vcc
    v_cndmask_b32 v14, v49, v50, vcc
    v_cmp_eq_u32 vcc, 3, v44
    s_nop 1
    v_cndmask_b32 v11, v49, v48, vcc
    v_cndmask_b32 v15, v49, v50, vcc
    v_lshrrev_b32 v44, 5, v1
    v_lshlrev_b32 v44, 10, v44
    v_bfe_u32 v45, v1, 3, 2
    v_lshl_add_u32 v44, v45, 8, v44
    v_and_b32 v45, 7, v1
    v_lshl_add_u32 v52, v45, 4, v44
    v_lshrrev_b32 v53, 3, v1
    v_lshlrev_b32 v53, 6, v53
    v_lshl_add_u32 v53, v45, 1, v53
    s_mov_b32 s89, 96
    s_mov_b32 s99, 0
    s_waitcnt lgkmcnt(0)
    v_mov_b32 v44, s94
    v_mov_b32 v45, s95
    ds_write_b64 v56, v[44:45] offset:24
    s_add_u32 s94, s94, 0x7f4a7c15
    s_addc_u32 s95, s95, 0x9e3779b9
    s_and_b32 s56, s94, 0xfff
    s_bfe_u32 s57, s94, 0xc000c
    s_lshr_b64 s[58:59], s[94:95], 24
    s_bfe_u32 s59, s58, 0xc000c
    s_and_b32 s58, s58, 0xfff
    s_add_u32 s88, s88, 1
    s_xor_b32 s88, s88, s59
    s_waitcnt vmcnt(0)
    s_mov_b64 s[72:73], s[24:25]
    s_sub_u32 s90, s90, 114688
    buffer_load_dwordx4 v[120:123], v4, s[72:75], s90 offen nt
    s_add_u32 s90, s90, s91
    buffer_load_dwordx4 v[124:127], v4, s[72:75], s90 offen nt
    s_add_u32 s90, s90, s91
    buffer_load_dwordx4 v[128:131], v4, s[72:75], s90 offen nt
    s_add_u32 s90, s90, s91
    buffer_load_dwordx4 v[132:135], v4, s[72:75], s90 offen nt
    s_add_u32 s90, s90, s91
    buffer_load_dwordx4 v[136:139], v4, s[72:75], s90 offen nt
    s_add_u32 s90, s90, s91
    buffer_load_dwordx4 v[140:143], v4, s[72:75], s90 offen nt
    s_add_u32 s90, s90, s91
    buffer_load_dwordx4 v[144:147], v4, s[72:75], s90 offen nt
    s_add_u32 s90, s90, s91
    buffer_load_dwordx4 v[148:151], v4, s[72:75], s90 offen nt
    s_add_u32 s90, s90, s91
    buffer_load_dwordx4 v[152:155], v4, s[72:75], s90 offen nt
    s_add_u32 s90, s90, s91
    buffer_load_dwordx4 v[156:159], v4, s[72:75], s90 offen nt
    s_add_u32 s90, s90, s91
    buffer_load_dwordx4 v[160:163], v4, s[72:75], s90 offen nt
    s_add_u32 s90, s90, s91
    buffer_load_dwordx4 v[164:167], v4, s[72:75], s90 offen nt
    s_add_u32 s90, s90, s91
    buffer_load_dwordx4 v[168:171], v4, s[72:75], s90 offen nt
    s_add_u32 s90, s90, s91
    buffer_load_dwordx4 v[172:175], v4, s[72:75], s90 offen nt
    s_add_u32 s90, s90, s91
    v_perm_b32 v36, v16, v16, v8
    v_perm_b32 v37, v16, v16, v9
    v_perm_b32 v38, v16, v16, v10
    v_perm_b32 v39, v16, v16, v11
    s_nop 1
    v_mfma_f32_16x16x32_bf16 v[32:35], v[64:67], v[36:39], 0
    v_perm_b32 v40, v16, v16, v12
    v_perm_b32 v41, v16, v16, v13
    v_perm_b32 v42, v16, v16, v14
    v_perm_b32 v43, v16, v16, v15
    s_nop 1
    v_mfma_f32_16x16x32_bf16 v[32:35], v[68:71], v[40:43], v[32:35]
    v_perm_b32 v36, v17, v17, v8
    v_perm_b32 v37, v17, v17, v9
    v_perm_b32 v38, v17, v17, v10
    v_perm_b32 v39, v17, v17, v11
    s_nop 1
    v_mfma_f32_16x16x32_bf16 v[32:35], v[72:75], v[36:39], v[32:35]
    v_perm_b32 v40, v17, v17, v12
    v_perm_b32 v41, v17, v17, v13
    v_perm_b32 v42, v17, v17, v14
    v_perm_b32 v43, v17, v17, v15
    s_nop 1
    v_mfma_f32_16x16x32_bf16 v[32:35], v[76:79], v[40:43], v[32:35]
    v_perm_b32 v36, v18, v18, v8
    v_perm_b32 v37, v18, v18, v9
    v_perm_b32 v38, v18, v18, v10
    v_perm_b32 v39, v18, v18, v11
    s_nop 1
    v_mfma_f32_16x16x32_bf16 v[32:35], v[80:83], v[36:39], v[32:35]
    v_perm_b32 v40, v18, v18, v12
    v_perm_b32 v41, v18, v18, v13
    v_perm_b32 v42, v18, v18, v14
    v_perm_b32 v43, v18, v18, v15
    s_nop 1
    v_mfma_f32_16x16x32_bf16 v[32:35], v[84:87], v[40:43], v[32:35]
    v_perm_b32 v36, v19, v19, v8
    v_perm_b32 v37, v19, v19, v9
    v_perm_b32 v38, v19, v19, v10
    v_perm_b32 v39, v19, v19, v11
    s_nop 1
    v_mfma_f32_16x16x32_bf16 v[32:35], v[88:91], v[36:39], v[32:35]
    v_perm_b32 v40, v19, v19, v12
    v_perm_b32 v41, v19, v19, v13
    v_perm_b32 v42, v19, v19, v14
    v_perm_b32 v43, v19, v19, v15
    s_nop 1
    v_mfma_f32_16x16x32_bf16 v[32:35], v[92:95], v[40:43], v[32:35]
    v_perm_b32 v36, v20, v20, v8
    v_perm_b32 v37, v20, v20, v9
    v_perm_b32 v38, v20, v20, v10
    v_perm_b32 v39, v20, v20, v11
    s_nop 1
    v_mfma_f32_16x16x32_bf16 v[32:35], v[96:99], v[36:39], v[32:35]
    v_perm_b32 v40, v20, v20, v12
    v_perm_b32 v41, v20, v20, v13
    v_perm_b32 v42, v20, v20, v14
    v_perm_b32 v43, v20, v20, v15
    s_nop 1
    v_mfma_f32_16x16x32_bf16 v[32:35], v[100:103], v[40:43], v[32:35]
    v_perm_b32 v36, v21, v21, v8
    v_perm_b32 v37, v21, v21, v9
    v_perm_b32 v38, v21, v21, v10
    v_perm_b32 v39, v21, v21, v11
    s_nop 1
    v_mfma_f32_16x16x32_bf16 v[32:35], v[104:107], v[36:39], v[32:35]
    v_perm_b32 v40, v21, v21, v12
    v_perm_b32 v41, v21, v21, v13
    v_perm_b32 v42, v21, v21, v14
    v_perm_b32 v43, v21, v21, v15
    s_nop 1
    v_mfma_f32_16x16x32_bf16 v[32:35], v[108:111], v[40:43], v[32:35]
    v_perm_b32 v36, v22, v22, v8
    v_perm_b32 v37, v22, v22, v9
    v_perm_b32 v38, v22, v22, v10
    v_perm_b32 v39, v22, v22, v11
    s_nop 1
    v_mfma_f32_16x16x32_bf16 v[32:35], v[112:115], v[36:39], v[32:35]
    v_perm_b32 v40, v22, v22, v12
    v_perm_b32 v41, v22, v22, v13
    v_perm_b32 v42, v22, v22, v14
    v_perm_b32 v43, v22, v22, v15
    s_nop 1
    v_mfma_f32_16x16x32_bf16 v[32:35], v[116:119], v[40:43], v[32:35]
    s_nop 7
    v_bfi_b32 v32, v251, s56, v32
    v_bfi_b32 v33, v251, s57, v33
    v_bfi_b32 v34, v251, s58, v34
    v_bfi_b32 v35, v251, s88, v35
    buffer_store_dwordx4 v[32:35], v2, s[80:83], s39 offen
    v_perm_b32 v36, v24, v24, v8
    v_perm_b32 v37, v24, v24, v9
    v_perm_b32 v38, v24, v24, v10
    v_perm_b32 v39, v24, v24, v11
    s_waitcnt vmcnt(13)
    s_nop 0
    v_mfma_f32_16x16x32_bf16 v[180:183], v[120:123], v[36:39], 0
    v_perm_b32 v40, v24, v24, v12
    v_perm_b32 v41, v24, v24, v13
    v_perm_b32 v42, v24, v24, v14
    v_perm_b32 v43, v24, v24, v15
    s_waitcnt vmcnt(12)
    s_nop 0
    v_mfma_f32_16x16x32_bf16 v[180:183], v[124:127], v[40:43], v[180:183]
    v_perm_b32 v36, v25, v25, v8
    v_perm_b32 v37, v25, v25, v9
    v_perm_b32 v38, v25, v25, v10
    v_perm_b32 v39, v25, v25, v11
    s_waitcnt vmcnt(11)
    s_nop 0
    v_mfma_f32_16x16x32_bf16 v[180:183], v[128:131], v[36:39], v[180:183]
    v_perm_b32 v40, v25, v25, v12
    v_perm_b32 v41, v25, v25, v13
    v_perm_b32 v42, v25, v25, v14
    v_perm_b32 v43, v25, v25, v15
    s_waitcnt vmcnt(10)
    s_nop 0
    v_mfma_f32_16x16x32_bf16 v[180:183], v[132:135], v[40:43], v[180:183]
    v_perm_b32 v36, v26, v26, v8
    v_perm_b32 v37, v26, v26, v9
    v_perm_b32 v38, v26, v26, v10
    v_perm_b32 v39, v26, v26, v11
    s_waitcnt vmcnt(9)
    s_nop 0
    v_mfma_f32_16x16x32_bf16 v[180:183], v[136:139], v[36:39], v[180:183]
    v_perm_b32 v40, v26, v26, v12
    v_perm_b32 v41, v26, v26, v13
    v_perm_b32 v42, v26, v26, v14
    v_perm_b32 v43, v26, v26, v15
    s_waitcnt vmcnt(8)
    s_nop 0
    v_mfma_f32_16x16x32_bf16 v[180:183], v[140:143], v[40:43], v[180:183]
    v_perm_b32 v36, v27, v27, v8
    v_perm_b32 v37, v27, v27, v9
    v_perm_b32 v38, v27, v27, v10
    v_perm_b32 v39, v27, v27, v11
    s_waitcnt vmcnt(7)
    s_nop 0
    v_mfma_f32_16x16x32_bf16 v[180:183], v[144:147], v[36:39], v[180:183]
    v_perm_b32 v40, v27, v27, v12
    v_perm_b32 v41, v27, v27, v13
    v_perm_b32 v42, v27, v27, v14
    v_perm_b32 v43, v27, v27, v15
    s_waitcnt vmcnt(6)
    s_nop 0
    v_mfma_f32_16x16x32_bf16 v[180:183], v[148:151], v[40:43], v[180:183]
    v_perm_b32 v36, v28, v28, v8
    v_perm_b32 v37, v28, v28, v9
    v_perm_b32 v38, v28, v28, v10
    v_perm_b32 v39, v28, v28, v11
    s_waitcnt vmcnt(5)
    s_nop 0
    v_mfma_f32_16x16x32_bf16 v[180:183], v[152:155], v[36:39], v[180:183]
    v_perm_b32 v40, v28, v28, v12
    v_perm_b32 v41, v28, v28, v13
    v_perm_b32 v42, v28, v28, v14
    v_perm_b32 v43, v28, v28, v15
    s_waitcnt vmcnt(4)
    s_nop 0
    v_mfma_f32_16x16x32_bf16 v[180:183], v[156:159], v[40:43], v[180:183]
    v_perm_b32 v36, v29, v29, v8
    v_perm_b32 v37, v29, v29, v9
    v_perm_b32 v38, v29, v29, v10
    v_perm_b32 v39, v29, v29, v11
    s_waitcnt vmcnt(3)
    s_nop 0
    v_mfma_f32_16x16x32_bf16 v[180:183], v[160:163], v[36:39], v[180:183]
    v_perm_b32 v40, v29, v29, v12
    v_perm_b32 v41, v29, v29, v13
    v_perm_b32 v42, v29, v29, v14
    v_perm_b32 v43, v29, v29, v15
    s_waitcnt vmcnt(2)
    s_nop 0
    v_mfma_f32_16x16x32_bf16 v[180:183], v[164:167], v[40:43], v[180:183]
    v_perm_b32 v36, v30, v30, v8
    v_perm_b32 v37, v30, v30, v9
    v_perm_b32 v38, v30, v30, v10
    v_perm_b32 v39, v30, v30, v11
    s_waitcnt vmcnt(1)
    s_nop 0
    v_mfma_f32_16x16x32_bf16 v[180:183], v[168:171], v[36:39], v[180:183]
    v_perm_b32 v40, v30, v30, v12
    v_perm_b32 v41, v30, v30, v13
    v_perm_b32 v42, v30, v30, v14
    v_perm_b32 v43, v30, v30, v15
    s_waitcnt vmcnt(0)
    s_nop 0
    v_mfma_f32_16x16x32_bf16 v[180:183], v[172:175], v[40:43], v[180:183]
    s_nop 7
    v_bfi_b32 v180, v251, s56, v180
    v_bfi_b32 v181, v251, s57, v181
    v_bfi_b32 v182, v251, s58, v182
    v_bfi_b32 v183, v251, s88, v183
    buffer_store_dwordx4 v[180:183], v2, s[80:83], s38 offen
L_qnt0:
    s_add_u32 s63, s34, 0
    buffer_load_dwordx4 v[190:193], v52, s[80:83], s63 offen offset:0 nt
    buffer_load_dwordx4 v[194:197], v52, s[80:83], s63 offen offset:2048 nt
    s_add_u32 s63, s34, 4096
    buffer_load_dwordx4 v[198:201], v52, s[80:83], s63 offen offset:0 nt
    buffer_load_dwordx4 v[202:205], v52, s[80:83], s63 offen offset:2048 nt
    s_add_u32 s63, s34, 8192
    buffer_load_dwordx4 v[206:209], v52, s[80:83], s63 offen offset:0 nt
    buffer_load_dwordx4 v[210:213], v52, s[80:83], s63 offen offset:2048 nt
    s_add_u32 s63, s34, 12288
    buffer_load_dwordx4 v[214:217], v52, s[80:83], s63 offen offset:0 nt
    buffer_load_dwordx4 v[218:221], v52, s[80:83], s63 offen offset:2048 nt
    s_branch L_qchk0
L_qpoll0:
    s_add_u32 s63, s34, 0
    buffer_load_dwordx4 v[190:193], v52, s[80:83], s63 offen offset:0 sc1
    buffer_load_dwordx4 v[194:197], v52, s[80:83], s63 offen offset:2048 sc1
    s_add_u32 s63, s34, 4096
    buffer_load_dwordx4 v[198:201], v52, s[80:83], s63 offen offset:0 sc1
    buffer_load_dwordx4 v[202:205], v52, s[80:83], s63 offen offset:2048 sc1
    s_add_u32 s63, s34, 8192
    buffer_load_dwordx4 v[206:209], v52, s[80:83], s63 offen offset:0 sc1
    buffer_load_dwordx4 v[210:213], v52, s[80:83], s63 offen offset:2048 sc1
    s_add_u32 s63, s34, 12288
    buffer_load_dwordx4 v[214:217], v52, s[80:83], s63 offen offset:0 sc1
    buffer_load_dwordx4 v[218:221], v52, s[80:83], s63 offen offset:2048 sc1
L_qchk0:
    s_sub_u32 s61, s61, 1
    s_waitcnt vmcnt(0)
    v_xor_b32 v190, s56, v190
    v_xor_b32 v191, s57, v191
    v_xor_b32 v192, s58, v192
    v_xor_b32 v193, s88, v193
    v_xor_b32 v194, s56, v194
    v_xor_b32 v195, s57, v195
    v_xor_b32 v196, s58, v196
    v_xor_b32 v197, s88, v197
    v_xor_b32 v198, s56, v198
    v_xor_b32 v199, s57, v199
    v_xor_b32 v200, s58, v200
    v_xor_b32 v201, s88, v201
    v_xor_b32 v202, s56, v202
    v_xor_b32 v203, s57, v203
    v_xor_b32 v204, s58, v204
    v_xor_b32 v205, s88, v205
    v_xor_b32 v206, s56, v206
    v_xor_b32 v207, s57, v207
    v_xor_b32 v208, s58, v208
    v_xor_b32 v209, s88, v209
    v_xor_b32 v210, s56, v210
    v_xor_b32 v211, s57, v211
    v_xor_b32 v212, s58, v212
    v_xor_b32 v213, s88, v213
    v_xor_b32 v214, s56, v214
    v_xor_b32 v215, s57, v215
    v_xor_b32 v216, s58, v216
    v_xor_b32 v217, s88, v217
    v_xor_b32 v218, s56, v218
    v_xor_b32 v219, s57, v219
    v_xor_b32 v220, s58, v220
    v_xor_b32 v221, s88, v221
    v_or3_b32 v48, v190, v191, v192
    v_or3_b32 v48, v48, v193, v194
    v_or3_b32 v48, v48, v195, v196
    v_or3_b32 v48, v48, v197, v198
    v_or3_b32 v48, v48, v199, v200
    v_or3_b32 v48, v48, v201, v202
    v_or3_b32 v48, v48, v203, v204
    v_or3_b32 v48, v48, v205, v206
    v_or3_b32 v48, v48, v207, v208
    v_or3_b32 v48, v48, v209, v210
    v_or3_b32 v48, v48, v211, v212
    v_or3_b32 v48, v48, v213, v214
    v_or3_b32 v48, v48, v215, v216
    v_or3_b32 v48, v48, v217, v218
    v_or3_b32 v48, v48, v219, v220
    v_or_b32 v48, v48, v221
    v_and_b32 v48, v251, v48
    v_cmp_ne_u32 vcc, 0, v48
    s_nop 0
    s_cbranch_vccz L_qgo0
    s_cmp_le_i32 s61, 0
    s_cbranch_scc1 L_qgo0
    s_cmp_eq_u32 s89, 0
    s_cbranch_scc1 L_qsafe0
    s_sub_u32 s89, s89, 1
    s_cmp_gt_u32 s89, 90
    s_cbranch_scc1 L_qnt0
    s_cmp_lg_u32 s89, 0
    s_cbranch_scc1 L_qpoll0
    v_bfi_b32 v32, v251, s56, v32
    v_bfi_b32 v33, v251, s57, v33
    v_bfi_b32 v34, v251, s58, v34
    v_bfi_b32 v35, v251, s59, v35
    s_add_u32 s63, s39, 1376256
    buffer_store_dwordx4 v[32:35], v2, s[80:83], s63 offen sc1
    v_bfi_b32 v180, v251, s56, v180
    v_bfi_b32 v181, v251, s57, v181
    v_bfi_b32 v182, v251, s58, v182
    v_bfi_b32 v183, v251, s59, v183
    s_add_u32 s63, s38, 1376256
    buffer_store_dwordx4 v[180:183], v2, s[80:83], s63 offen sc1
L_qsafe0:
    s_add_u32 s63, s34, 1376256
    buffer_load_dwordx4 v[190:193], v52, s[80:83], s63 offen offset:0 sc1
    buffer_load_dwordx4 v[194:197], v52, s[80:83], s63 offen offset:2048 sc1
    s_add_u32 s63, s34, 1380352
    buffer_load_dwordx4 v[198:201], v52, s[80:83], s63 offen offset:0 sc1
    buffer_load_dwordx4 v[202:205], v52, s[80:83], s63 offen offset:2048 sc1
    s_add_u32 s63, s34, 1384448
    buffer_load_dwordx4 v[206:209], v52, s[80:83], s63 offen offset:0 sc1
    buffer_load_dwordx4 v[210:213], v52, s[80:83], s63 offen offset:2048 sc1
    s_add_u32 s63, s34, 1388544
    buffer_load_dwordx4 v[214:217], v52, s[80:83], s63 offen offset:0 sc1
    buffer_load_dwordx4 v[218:221], v52, s[80:83], s63 offen offset:2048 sc1
    s_waitcnt vmcnt(0)
    v_xor_b32 v190, s56, v190
    v_xor_b32 v191, s57, v191
    v_xor_b32 v192, s58, v192
    v_xor_b32 v193, s59, v193
    v_xor_b32 v194, s56, v194
    v_xor_b32 v195, s57, v195
    v_xor_b32 v196, s58, v196
    v_xor_b32 v197, s59, v197
    v_xor_b32 v198, s56, v198
    v_xor_b32 v199, s57, v199
    v_xor_b32 v200, s58, v200
    v_xor_b32 v201, s59, v201
    v_xor_b32 v202, s56, v202
    v_xor_b32 v203, s57, v203
    v_xor_b32 v204, s58, v204
    v_xor_b32 v205, s59, v205
    v_xor_b32 v206, s56, v206
    v_xor_b32 v207, s57, v207
    v_xor_b32 v208, s58, v208
    v_xor_b32 v209, s59, v209
    v_xor_b32 v210, s56, v210
    v_xor_b32 v211, s57, v211
    v_xor_b32 v212, s58, v212
    v_xor_b32 v213, s59, v213
    v_xor_b32 v214, s56, v214
    v_xor_b32 v215, s57, v215
    v_xor_b32 v216, s58, v216
    v_xor_b32 v217, s59, v217
    v_xor_b32 v218, s56, v218
    v_xor_b32 v219, s57, v219
    v_xor_b32 v220, s58, v220
    v_xor_b32 v221, s59, v221
    v_or3_b32 v48, v190, v191, v192
    v_or3_b32 v48, v48, v193, v194
    v_or3_b32 v48, v48, v195, v196
    v_or3_b32 v48, v48, v197, v198
    v_or3_b32 v48, v48, v199, v200
    v_or3_b32 v48, v48, v201, v202
    v_or3_b32 v48, v48, v203, v204
    v_or3_b32 v48, v48, v205, v206
    v_or3_b32 v48, v48, v207, v208
    v_or3_b32 v48, v48, v209, v210
    v_or3_b32 v48, v48, v211, v212
    v_or3_b32 v48, v48, v213, v214
    v_or3_b32 v48, v48, v215, v216
    v_or3_b32 v48, v48, v217, v218
    v_or3_b32 v48, v48, v219, v220
    v_or_b32 v48, v48, v221
    v_and_b32 v48, v251, v48
    v_cmp_ne_u32 vcc, 0, v48
    s_nop 0
    s_cbranch_vccnz L_qpoll0
    s_mov_b32 s99, 1
L_qgo0:
    v_add_f32 v190, v190, v206
    v_add_f32 v191, v191, v207
    v_add_f32 v192, v192, v208
    v_add_f32 v193, v193, v209
    v_add_f32 v194, v194, v210
    v_add_f32 v195, v195, v211
    v_add_f32 v196, v196, v212
    v_add_f32 v197, v197, v213
    v_add_f32 v198, v198, v214
    v_add_f32 v199, v199, v215
    v_add_f32 v200, v200, v216
    v_add_f32 v201, v201, v217
    v_add_f32 v202, v202, v218
    v_add_f32 v203, v203, v219
    v_add_f32 v204, v204, v220
    v_add_f32 v205, v205, v221
    v_add_f32 v190, v190, v198
    v_add_f32 v191, v191, v199
    v_add_f32 v192, v192, v200
    v_add_f32 v193, v193, v201
    v_add_f32 v194, v194, v202
    v_add_f32 v195, v195, v203
    v_add_f32 v196, v196, v204
    v_add_f32 v197, v197, v205
    v_add_f32 v190, v190, v194
    v_add_f32 v191, v191, v195
    v_add_f32 v192, v192, v196
    v_add_f32 v193, v193, v197
    v_cvt_pk_bf16_f32 v190, v190, v191
    v_cvt_pk_bf16_f32 v192, v192, v193
    ds_write_b16 v53, v190 offset:0
    ds_write_b16_d16_hi v53, v190 offset:16
    ds_write_b16 v53, v192 offset:32
    ds_write_b16_d16_hi v53, v192 offset:48
    v_mov_b32 v55, 131072
    s_mov_b64 exec, 1
    ds_add_u32 v56, v55
    s_mov_b64 exec, -1
L_qnt1:
    s_add_u32 s63, s34, 16384
    buffer_load_dwordx4 v[190:193], v52, s[80:83], s63 offen offset:0 nt
    buffer_load_dwordx4 v[194:197], v52, s[80:83], s63 offen offset:2048 nt
    s_add_u32 s63, s34, 20480
    buffer_load_dwordx4 v[198:201], v52, s[80:83], s63 offen offset:0 nt
    buffer_load_dwordx4 v[202:205], v52, s[80:83], s63 offen offset:2048 nt
    s_add_u32 s63, s34, 24576
    buffer_load_dwordx4 v[206:209], v52, s[80:83], s63 offen offset:0 nt
    buffer_load_dwordx4 v[210:213], v52, s[80:83], s63 offen offset:2048 nt
    s_add_u32 s63, s34, 28672
    buffer_load_dwordx4 v[214:217], v52, s[80:83], s63 offen offset:0 nt
    buffer_load_dwordx4 v[218:221], v52, s[80:83], s63 offen offset:2048 nt
    s_branch L_qchk1
L_qpoll1:
    s_add_u32 s63, s34, 16384
    buffer_load_dwordx4 v[190:193], v52, s[80:83], s63 offen offset:0 sc1
    buffer_load_dwordx4 v[194:197], v52, s[80:83], s63 offen offset:2048 sc1
    s_add_u32 s63, s34, 20480
    buffer_load_dwordx4 v[198:201], v52, s[80:83], s63 offen offset:0 sc1
    buffer_load_dwordx4 v[202:205], v52, s[80:83], s63 offen offset:2048 sc1
    s_add_u32 s63, s34, 24576
    buffer_load_dwordx4 v[206:209], v52, s[80:83], s63 offen offset:0 sc1
    buffer_load_dwordx4 v[210:213], v52, s[80:83], s63 offen offset:2048 sc1
    s_add_u32 s63, s34, 28672
    buffer_load_dwordx4 v[214:217], v52, s[80:83], s63 offen offset:0 sc1
    buffer_load_dwordx4 v[218:221], v52, s[80:83], s63 offen offset:2048 sc1
L_qchk1:
    s_sub_u32 s61, s61, 1
    s_waitcnt vmcnt(0)
    v_xor_b32 v190, s56, v190
    v_xor_b32 v191, s57, v191
    v_xor_b32 v192, s58, v192
    v_xor_b32 v193, s88, v193
    v_xor_b32 v194, s56, v194
    v_xor_b32 v195, s57, v195
    v_xor_b32 v196, s58, v196
    v_xor_b32 v197, s88, v197
    v_xor_b32 v198, s56, v198
    v_xor_b32 v199, s57, v199
    v_xor_b32 v200, s58, v200
    v_xor_b32 v201, s88, v201
    v_xor_b32 v202, s56, v202
    v_xor_b32 v203, s57, v203
    v_xor_b32 v204, s58, v204
    v_xor_b32 v205, s88, v205
    v_xor_b32 v206, s56, v206
    v_xor_b32 v207, s57, v207
    v_xor_b32 v208, s58, v208
    v_xor_b32 v209, s88, v209
    v_xor_b32 v210, s56, v210
    v_xor_b32 v211, s57, v211
    v_xor_b32 v212, s58, v212
    v_xor_b32 v213, s88, v213
    v_xor_b32 v214, s56, v214
    v_xor_b32 v215, s57, v215
    v_xor_b32 v216, s58, v216
    v_xor_b32 v217, s88, v217
    v_xor_b32 v218, s56, v218
    v_xor_b32 v219, s57, v219
    v_xor_b32 v220, s58, v220
    v_xor_b32 v221, s88, v221
    v_or3_b32 v48, v190, v191, v192
    v_or3_b32 v48, v48, v193, v194
    v_or3_b32 v48, v48, v195, v196
    v_or3_b32 v48, v48, v197, v198
    v_or3_b32 v48, v48, v199, v200
    v_or3_b32 v48, v48, v201, v202
    v_or3_b32 v48, v48, v203, v204
    v_or3_b32 v48, v48, v205, v206
    v_or3_b32 v48, v48, v207, v208
    v_or3_b32 v48, v48, v209, v210
    v_or3_b32 v48, v48, v211, v212
    v_or3_b32 v48, v48, v213, v214
    v_or3_b32 v48, v48, v215, v216
    v_or3_b32 v48, v48, v217, v218
    v_or3_b32 v48, v48, v219, v220
    v_or_b32 v48, v48, v221
    v_and_b32 v48, v251, v48
    v_cmp_ne_u32 vcc, 0, v48
    s_nop 0
    s_cbranch_vccz L_qgo1
    s_cmp_le_i32 s61, 0
    s_cbranch_scc1 L_qgo1
    s_cmp_eq_u32 s89, 0
    s_cbranch_scc1 L_qsafe1
    s_sub_u32 s89, s89, 1
    s_cmp_gt_u32 s89, 90
    s_cbranch_scc1 L_qnt1
    s_cmp_lg_u32 s89, 0
    s_cbranch_scc1 L_qpoll1
    v_bfi_b32 v32, v251, s56, v32
    v_bfi_b32 v33, v251, s57, v33
    v_bfi_b32 v34, v251, s58, v34
    v_bfi_b32 v35, v251, s59, v35
    s_add_u32 s63, s39, 1376256
    buffer_store_dwordx4 v[32:35], v2, s[80:83], s63 offen sc1
    v_bfi_b32 v180, v251, s56, v180
    v_bfi_b32 v181, v251, s57, v181
    v_bfi_b32 v182, v251, s58, v182
    v_bfi_b32 v183, v251, s59, v183
    s_add_u32 s63, s38, 1376256
    buffer_store_dwordx4 v[180:183], v2, s[80:83], s63 offen sc1
L_qsafe1:
    s_add_u32 s63, s34, 1392640
    buffer_load_dwordx4 v[190:193], v52, s[80:83], s63 offen offset:0 sc1
    buffer_load_dwordx4 v[194:197], v52, s[80:83], s63 offen offset:2048 sc1
    s_add_u32 s63, s34, 1396736
    buffer_load_dwordx4 v[198:201], v52, s[80:83], s63 offen offset:0 sc1
    buffer_load_dwordx4 v[202:205], v52, s[80:83], s63 offen offset:2048 sc1
    s_add_u32 s63, s34, 1400832
    buffer_load_dwordx4 v[206:209], v52, s[80:83], s63 offen offset:0 sc1
    buffer_load_dwordx4 v[210:213], v52, s[80:83], s63 offen offset:2048 sc1
    s_add_u32 s63, s34, 1404928
    buffer_load_dwordx4 v[214:217], v52, s[80:83], s63 offen offset:0 sc1
    buffer_load_dwordx4 v[218:221], v52, s[80:83], s63 offen offset:2048 sc1
    s_waitcnt vmcnt(0)
    v_xor_b32 v190, s56, v190
    v_xor_b32 v191, s57, v191
    v_xor_b32 v192, s58, v192
    v_xor_b32 v193, s59, v193
    v_xor_b32 v194, s56, v194
    v_xor_b32 v195, s57, v195
    v_xor_b32 v196, s58, v196
    v_xor_b32 v197, s59, v197
    v_xor_b32 v198, s56, v198
    v_xor_b32 v199, s57, v199
    v_xor_b32 v200, s58, v200
    v_xor_b32 v201, s59, v201
    v_xor_b32 v202, s56, v202
    v_xor_b32 v203, s57, v203
    v_xor_b32 v204, s58, v204
    v_xor_b32 v205, s59, v205
    v_xor_b32 v206, s56, v206
    v_xor_b32 v207, s57, v207
    v_xor_b32 v208, s58, v208
    v_xor_b32 v209, s59, v209
    v_xor_b32 v210, s56, v210
    v_xor_b32 v211, s57, v211
    v_xor_b32 v212, s58, v212
    v_xor_b32 v213, s59, v213
    v_xor_b32 v214, s56, v214
    v_xor_b32 v215, s57, v215
    v_xor_b32 v216, s58, v216
    v_xor_b32 v217, s59, v217
    v_xor_b32 v218, s56, v218
    v_xor_b32 v219, s57, v219
    v_xor_b32 v220, s58, v220
    v_xor_b32 v221, s59, v221
    v_or3_b32 v48, v190, v191, v192
    v_or3_b32 v48, v48, v193, v194
    v_or3_b32 v48, v48, v195, v196
    v_or3_b32 v48, v48, v197, v198
    v_or3_b32 v48, v48, v199, v200
    v_or3_b32 v48, v48, v201, v202
    v_or3_b32 v48, v48, v203, v204
    v_or3_b32 v48, v48, v205, v206
    v_or3_b32 v48, v48, v207, v208
    v_or3_b32 v48, v48, v209, v210
    v_or3_b32 v48, v48, v211, v212
    v_or3_b32 v48, v48, v213, v214
    v_or3_b32 v48, v48, v215, v216
    v_or3_b32 v48, v48, v217, v218
    v_or3_b32 v48, v48, v219, v220
    v_or_b32 v48, v48, v221
    v_and_b32 v48, v251, v48
    v_cmp_ne_u32 vcc, 0, v48
    s_nop 0
    s_cbranch_vccnz L_qpoll1
    s_mov_b32 s99, 1
L_qgo1:
    v_add_f32 v190, v190, v206
    v_add_f32 v191, v191, v207
    v_add_f32 v192, v192, v208
    v_add_f32 v193, v193, v209
    v_add_f32 v194, v194, v210
    v_add_f32 v195, v195, v211
    v_add_f32 v196, v196, v212
    v_add_f32 v197, v197, v213
    v_add_f32 v198, v198, v214
    v_add_f32 v199, v199, v215
    v_add_f32 v200, v200, v216
    v_add_f32 v201, v201, v217
    v_add_f32 v202, v202, v218
    v_add_f32 v203, v203, v219
    v_add_f32 v204, v204, v220
    v_add_f32 v205, v205, v221
    v_add_f32 v190, v190, v198
    v_add_f32 v191, v191, v199
    v_add_f32 v192, v192, v200
    v_add_f32 v193, v193, v201
    v_add_f32 v194, v194, v202
    v_add_f32 v195, v195, v203
    v_add_f32 v196, v196, v204
    v_add_f32 v197, v197, v205
    v_add_f32 v190, v190, v194
    v_add_f32 v191, v191, v195
    v_add_f32 v192, v192, v196
    v_add_f32 v193, v193, v197
    v_cvt_pk_bf16_f32 v190, v190, v191
    v_cvt_pk_bf16_f32 v192, v192, v193
    ds_write_b16 v53, v190 offset:512
    ds_write_b16_d16_hi v53, v190 offset:528
    ds_write_b16 v53, v192 offset:544
    ds_write_b16_d16_hi v53, v192 offset:560
    s_lshl_b32 s63, s99, 20
    s_or_b32 s63, s63, 524288
    v_mov_b32 v55, s63
    s_mov_b64 exec, 1
    ds_add_u32 v56, v55
    s_mov_b64 exec, -1
    v_and_b32 v46, 1, v1
    v_lshlrev_b32 v46, 4, v46
    v_mov_b32 v47, 0xffff
    v_lshlrev_b32 v47, v46, v47
    s_branch L_tset
L_drain:
    s_ff1_i32_b32 s7, s71
    s_bitset0_b32 s71, s7
    s_lshl_b32 s63, s7, 13
    v_add_u32 v52, s63, v2
    ds_read_b128 v[96:99], v52 offset:8192
    ds_read_b128 v[100:103], v52 offset:9216
    ds_read_b128 v[104:107], v52 offset:10240
    ds_read_b128 v[108:111], v52 offset:11264
    ds_read_b128 v[112:115], v52 offset:12288
    ds_read_b128 v[116:119], v52 offset:13312
    ds_read_b128 v[120:123], v52 offset:14336
    ds_read_b128 v[124:127], v52 offset:15360
    s_add_u32 s93, s7, s35
    s_and_b32 s93, s93, 31
    s_lshl_b32 s93, s93, 6
    s_waitcnt lgkmcnt(0)
L_K0Y:
    v_add_u32 v52, s93, v10
    s_waitcnt vmcnt(12)
    v_dot2_f32_bf16 v44, v96, v6, 0
    v_dot2_f32_bf16 v45, v100, v6, 0
    v_dot2_f32_bf16 v46, v104, v6, 0
    v_dot2_f32_bf16 v47, v108, v6, 0
    v_dot2_f32_bf16 v44, v97, v7, v44
    v_dot2_f32_bf16 v45, v101, v7, v45
    v_dot2_f32_bf16 v46, v105, v7, v46
    v_dot2_f32_bf16 v47, v109, v7, v47
    v_dot2_f32_bf16 v44, v98, v8, v44
    v_dot2_f32_bf16 v45, v102, v8, v45
    v_dot2_f32_bf16 v46, v106, v8, v46
    v_dot2_f32_bf16 v47, v110, v8, v47
    v_dot2_f32_bf16 v44, v99, v9, v44
    v_dot2_f32_bf16 v45, v103, v9, v45
    v_dot2_f32_bf16 v46, v107, v9, v46
    v_dot2_f32_bf16 v47, v111, v9, v47
    s_waitcnt vmcnt(8)
    v_dot2_f32_bf16 v48, v112, v6, 0
    v_dot2_f32_bf16 v49, v116, v6, 0
    v_dot2_f32_bf16 v50, v120, v6, 0
    v_dot2_f32_bf16 v51, v124, v6, 0
    v_dot2_f32_bf16 v48, v113, v7, v48
    v_dot2_f32_bf16 v49, v117, v7, v49
    v_dot2_f32_bf16 v50, v121, v7, v50
    v_dot2_f32_bf16 v51, v125, v7, v51
    v_dot2_f32_bf16 v48, v114, v8, v48
    v_dot2_f32_bf16 v49, v118, v8, v49
    v_dot2_f32_bf16 v50, v122, v8, v50
    v_dot2_f32_bf16 v51, v126, v8, v51
    v_dot2_f32_bf16 v48, v115, v9, v48
    v_dot2_f32_bf16 v49, v119, v9, v49
    v_dot2_f32_bf16 v50, v123, v9, v50
    v_dot2_f32_bf16 v51, v127, v9, v51
    v_permlane16_swap_b32 v44, v45
    v_permlane16_swap_b32 v46, v47
    v_permlane16_swap_b32 v48, v49
    v_permlane16_swap_b32 v50, v51
    v_add_f32 v44, v44, v45
    v_add_f32 v46, v46, v47
    v_add_f32 v48, v48, v49
    v_add_f32 v50, v50, v51
    v_add_f32_dpp v45, v44, v44 row_ror:8 row_mask:0xf bank_mask:0x3
    v_add_f32_dpp v47, v48, v48 row_ror:8 row_mask:0xf bank_mask:0x3
    s_nop 0
    v_add_f32_dpp v45, v46, v46 row_ror:8 row_mask:0xf bank_mask:0xc
    v_add_f32_dpp v47, v50, v50 row_ror:8 row_mask:0xf bank_mask:0xc
    s_nop 0
    v_add_f32_dpp v44, v45, v45 row_half_mirror row_mask:0xf bank_mask:0x5
    s_nop 1
    v_add_f32_dpp v44, v47, v47 row_half_mirror row_mask:0xf bank_mask:0xa
    s_nop 1
    v_add_f32_dpp v44, v44, v44 quad_perm:[1,0,3,2] row_mask:0xf bank_mask:0xf
    s_nop 1
    v_add_f32_dpp v44, v44, v44 quad_perm:[2,3,0,1] row_mask:0xf bank_mask:0xf
    ds_write_b32 v52, v44 offset:2048
    s_xor_b32 s70, s70, 1
    s_cbranch_scc1 L_K0c
    s_cmp_lt_u32 s37, s38
    s_cbranch_scc1 L_K0
    s_branch L_K0c
L_K0B:
    s_mov_b64 exec, 1
    ds_add_rtn_u32 v59, v56, v58
    s_mov_b64 exec, -1
    s_waitcnt lgkmcnt(0)
    v_readfirstlane_b32 s36, v59
    s_bitcmp1_b32 s36, 5
    s_cselect_b64 s[64:65], s[20:21], s[10:11]
    s_cselect_b64 s[68:69], s[22:23], s[12:13]
    s_bitcmp1_b32 s36, 6
    s_cselect_b64 s[64:65], s[68:69], s[64:65]
    s_and_b32 s37, s36, 0xff
    s_add_u32 s90, s36, s35
    s_and_b32 s93, s90, 31
    s_and_b32 s7, s90, 1
    s_lshr_b32 s90, s93, 1
    s_lshl_b32 s90, s90, 17
    s_lshl_b32 s7, s7, 13
    s_add_u32 s90, s90, s34
    s_add_u32 s90, s90, s7
    s_add_u32 s91, s90, 4096
    s_lshl_b32 s93, s93, 6
    s_cmp_ge_u32 s37, s38
    s_cbranch_scc1 L_K0X
    buffer_load_dwordx4 v[96:99], v2, s[64:67], s90 offen offset:0 nt
    buffer_load_dwordx4 v[100:103], v2, s[64:67], s90 offen offset:1024 nt
    buffer_load_dwordx4 v[104:107], v2, s[64:67], s90 offen offset:2048 nt
    buffer_load_dwordx4 v[108:111], v2, s[64:67], s90 offen offset:3072 nt
    buffer_load_dwordx4 v[112:115], v2, s[64:67], s91 offen offset:0 nt
    buffer_load_dwordx4 v[116:119], v2, s[64:67], s91 offen offset:1024 nt
    buffer_load_dwordx4 v[120:123], v2, s[64:67], s91 offen offset:2048 nt
    buffer_load_dwordx4 v[124:127], v2, s[64:67], s91 offen offset:3072 nt
L_K02:
    v_add_u32 v52, s92, v10
    s_waitcnt vmcnt(12)
    s_mov_b64 exec, 1
    ds_add_rtn_u32 v59, v56, v58
    s_mov_b64 exec, -1
    v_dot2_f32_bf16 v44, v64, v6, 0
    v_dot2_f32_bf16 v45, v68, v6, 0
    v_dot2_f32_bf16 v46, v72, v6, 0
    v_dot2_f32_bf16 v47, v76, v6, 0
    v_dot2_f32_bf16 v44, v65, v7, v44
    v_dot2_f32_bf16 v45, v69, v7, v45
    v_dot2_f32_bf16 v46, v73, v7, v46
    v_dot2_f32_bf16 v47, v77, v7, v47
    v_dot2_f32_bf16 v44, v66, v8, v44
    v_dot2_f32_bf16 v45, v70, v8, v45
    v_dot2_f32_bf16 v46, v74, v8, v46
    v_dot2_f32_bf16 v47, v78, v8, v47
    v_dot2_f32_bf16 v44, v67, v9, v44
    v_dot2_f32_bf16 v45, v71, v9, v45
    v_dot2_f32_bf16 v46, v75, v9, v46
    v_dot2_f32_bf16 v47, v79, v9, v47
    s_waitcnt lgkmcnt(0)
    v_readfirstlane_b32 s36, v59
    s_bitcmp1_b32 s36, 5
    s_cselect_b64 s[64:65], s[20:21], s[10:11]
    s_cselect_b64 s[68:69], s[22:23], s[12:13]
    s_bitcmp1_b32 s36, 6
    s_cselect_b64 s[64:65], s[68:69], s[64:65]
    s_and_b32 s37, s36, 0xff
    s_add_u32 s90, s36, s35
    s_and_b32 s92, s90, 31
    s_and_b32 s7, s90, 1
    s_lshr_b32 s90, s92, 1
    s_lshl_b32 s90, s90, 17
    s_lshl_b32 s7, s7, 13
    s_add_u32 s90, s90, s34
    s_add_u32 s90, s90, s7
    s_add_u32 s91, s90, 4096
    s_lshl_b32 s92, s92, 6
    s_waitcnt vmcnt(8)
    v_dot2_f32_bf16 v48, v80, v6, 0
    v_dot2_f32_bf16 v49, v84, v6, 0
    v_dot2_f32_bf16 v50, v88, v6, 0
    v_dot2_f32_bf16 v51, v92, v6, 0
    v_dot2_f32_bf16 v48, v81, v7, v48
    v_dot2_f32_bf16 v49, v85, v7, v49
    v_dot2_f32_bf16 v50, v89, v7, v50
    v_dot2_f32_bf16 v51, v93, v7, v51
    v_dot2_f32_bf16 v48, v82, v8, v48
    v_dot2_f32_bf16 v49, v86, v8, v49
    v_dot2_f32_bf16 v50, v90, v8, v50
    v_dot2_f32_bf16 v51, v94, v8, v51
    v_dot2_f32_bf16 v48, v83, v9, v48
    v_dot2_f32_bf16 v49, v87, v9, v49
    v_dot2_f32_bf16 v50, v91, v9, v50
    v_dot2_f32_bf16 v51, v95, v9, v51
    buffer_load_dwordx4 v[64:67], v2, s[64:67], s90 offen offset:0 nt
    buffer_load_dwordx4 v[68:71], v2, s[64:67], s90 offen offset:1024 nt
    buffer_load_dwordx4 v[72:75], v2, s[64:67], s90 offen offset:2048 nt
    buffer_load_dwordx4 v[76:79], v2, s[64:67], s90 offen offset:3072 nt
    buffer_load_dwordx4 v[80:83], v2, s[64:67], s91 offen offset:0 nt
    buffer_load_dwordx4 v[84:87], v2, s[64:67], s91 offen offset:1024 nt
    buffer_load_dwordx4 v[88:91], v2, s[64:67], s91 offen offset:2048 nt
    buffer_load_dwordx4 v[92:95], v2, s[64:67], s91 offen offset:3072 nt
    v_permlane16_swap_b32 v44, v45
    v_permlane16_swap_b32 v46, v47
    v_permlane16_swap_b32 v48, v49
    v_permlane16_swap_b32 v50, v51
    v_add_f32 v44, v44, v45
    v_add_f32 v46, v46, v47
    v_add_f32 v48, v48, v49
    v_add_f32 v50, v50, v51
    v_add_f32_dpp v45, v44, v44 row_ror:8 row_mask:0xf bank_mask:0x3
    v_add_f32_dpp v47, v48, v48 row_ror:8 row_mask:0xf bank_mask:0x3
    s_nop 0
    v_add_f32_dpp v45, v46, v46 row_ror:8 row_mask:0xf bank_mask:0xc
    v_add_f32_dpp v47, v50, v50 row_ror:8 row_mask:0xf bank_mask:0xc
    s_nop 0
    v_add_f32_dpp v44, v45, v45 row_half_mirror row_mask:0xf bank_mask:0x5
    s_nop 1
    v_add_f32_dpp v44, v47, v47 row_half_mirror row_mask:0xf bank_mask:0xa
    s_nop 1
    v_add_f32_dpp v44, v44, v44 quad_perm:[1,0,3,2] row_mask:0xf bank_mask:0xf
    s_nop 1
    v_add_f32_dpp v44, v44, v44 quad_perm:[2,3,0,1] row_mask:0xf bank_mask:0xf
    ds_write_b32 v52, v44 offset:2048
    s_lshr_b32 s63, s36, 24
    s_sub_i32 s63, s63, s89
    s_min_i32 s63, s63, s38
    s_cmp_ge_i32 s37, s63
    s_cbranch_scc1 L_K0Y
    v_add_u32 v52, s93, v10
    s_waitcnt vmcnt(12)
    s_mov_b64 exec, 1
    ds_add_rtn_u32 v59, v56, v58
    s_mov_b64 exec, -1
    v_dot2_f32_bf16 v44, v96, v6, 0
    v_dot2_f32_bf16 v45, v100, v6, 0
    v_dot2_f32_bf16 v46, v104, v6, 0
    v_dot2_f32_bf16 v47, v108, v6, 0
    v_dot2_f32_bf16 v44, v97, v7, v44
    v_dot2_f32_bf16 v45, v101, v7, v45
    v_dot2_f32_bf16 v46, v105, v7, v46
    v_dot2_f32_bf16 v47, v109, v7, v47
    v_dot2_f32_bf16 v44, v98, v8, v44
    v_dot2_f32_bf16 v45, v102, v8, v45
    v_dot2_f32_bf16 v46, v106, v8, v46
    v_dot2_f32_bf16 v47, v110, v8, v47
    v_dot2_f32_bf16 v44, v99, v9, v44
    v_dot2_f32_bf16 v45, v103, v9, v45
    v_dot2_f32_bf16 v46, v107, v9, v46
    v_dot2_f32_bf16 v47, v111, v9, v47
    s_waitcnt lgkmcnt(0)
    v_readfirstlane_b32 s36, v59
    s_bitcmp1_b32 s36, 5
    s_cselect_b64 s[64:65], s[20:21], s[10:11]
    s_cselect_b64 s[68:69], s[22:23], s[12:13]
    s_bitcmp1_b32 s36, 6
    s_cselect_b64 s[64:65], s[68:69], s[64:65]
    s_and_b32 s37, s36, 0xff
    s_add_u32 s90, s36, s35
    s_and_b32 s93, s90, 31
    s_and_b32 s7, s90, 1
    s_lshr_b32 s90, s93, 1
    s_lshl_b32 s90, s90, 17
    s_lshl_b32 s7, s7, 13
    s_add_u32 s90, s90, s34
    s_add_u32 s90, s90, s7
    s_add_u32 s91, s90, 4096
    s_lshl_b32 s93, s93, 6
    s_waitcnt vmcnt(8)
    v_dot2_f32_bf16 v48, v112, v6, 0
    v_dot2_f32_bf16 v49, v116, v6, 0
    v_dot2_f32_bf16 v50, v120, v6, 0
    v_dot2_f32_bf16 v51, v124, v6, 0
    v_dot2_f32_bf16 v48, v113, v7, v48
    v_dot2_f32_bf16 v49, v117, v7, v49
    v_dot2_f32_bf16 v50, v121, v7, v50
    v_dot2_f32_bf16 v51, v125, v7, v51
    v_dot2_f32_bf16 v48, v114, v8, v48
    v_dot2_f32_bf16 v49, v118, v8, v49
    v_dot2_f32_bf16 v50, v122, v8, v50
    v_dot2_f32_bf16 v51, v126, v8, v51
    v_dot2_f32_bf16 v48, v115, v9, v48
    v_dot2_f32_bf16 v49, v119, v9, v49
    v_dot2_f32_bf16 v50, v123, v9, v50
    v_dot2_f32_bf16 v51, v127, v9, v51
    s_cmp_ge_u32 s37, s38
    s_cbranch_scc1 L_sk1
    buffer_load_dwordx4 v[96:99], v2, s[64:67], s90 offen offset:0 nt
    buffer_load_dwordx4 v[100:103], v2, s[64:67], s90 offen offset:1024 nt
    buffer_load_dwordx4 v[104:107], v2, s[64:67], s90 offen offset:2048 nt
    buffer_load_dwordx4 v[108:111], v2, s[64:67], s90 offen offset:3072 nt
    buffer_load_dwordx4 v[112:115], v2, s[64:67], s91 offen offset:0 nt
    buffer_load_dwordx4 v[116:119], v2, s[64:67], s91 offen offset:1024 nt
    buffer_load_dwordx4 v[120:123], v2, s[64:67], s91 offen offset:2048 nt
    buffer_load_dwordx4 v[124:127], v2, s[64:67], s91 offen offset:3072 nt
L_sk1:
    s_nop 2
    v_permlane16_swap_b32 v44, v45
    v_permlane16_swap_b32 v46, v47
    v_permlane16_swap_b32 v48, v49
    v_permlane16_swap_b32 v50, v51
    v_add_f32 v44, v44, v45
    v_add_f32 v46, v46, v47
    v_add_f32 v48, v48, v49
    v_add_f32 v50, v50, v51
    v_add_f32_dpp v45, v44, v44 row_ror:8 row_mask:0xf bank_mask:0x3
    v_add_f32_dpp v47, v48, v48 row_ror:8 row_mask:0xf bank_mask:0x3
    s_nop 0
    v_add_f32_dpp v45, v46, v46 row_ror:8 row_mask:0xf bank_mask:0xc
    v_add_f32_dpp v47, v50, v50 row_ror:8 row_mask:0xf bank_mask:0xc
    s_nop 0
    v_add_f32_dpp v44, v45, v45 row_half_mirror row_mask:0xf bank_mask:0x5
    s_nop 1
    v_add_f32_dpp v44, v47, v47 row_half_mirror row_mask:0xf bank_mask:0xa
    s_nop 1
    v_add_f32_dpp v44, v44, v44 quad_perm:[1,0,3,2] row_mask:0xf bank_mask:0xf
    s_nop 1
    v_add_f32_dpp v44, v44, v44 quad_perm:[2,3,0,1] row_mask:0xf bank_mask:0xf
    ds_write_b32 v52, v44 offset:2048
    s_cbranch_scc0 L_K02
L_K0X:
    v_add_u32 v52, s92, v10
    s_waitcnt vmcnt(4)
    v_dot2_f32_bf16 v44, v64, v6, 0
    v_dot2_f32_bf16 v45, v68, v6, 0
    v_dot2_f32_bf16 v46, v72, v6, 0
    v_dot2_f32_bf16 v47, v76, v6, 0
    v_dot2_f32_bf16 v44, v65, v7, v44
    v_dot2_f32_bf16 v45, v69, v7, v45
    v_dot2_f32_bf16 v46, v73, v7, v46
    v_dot2_f32_bf16 v47, v77, v7, v47
    v_dot2_f32_bf16 v44, v66, v8, v44
    v_dot2_f32_bf16 v45, v70, v8, v45
    v_dot2_f32_bf16 v46, v74, v8, v46
    v_dot2_f32_bf16 v47, v78, v8, v47
    v_dot2_f32_bf16 v44, v67, v9, v44
    v_dot2_f32_bf16 v45, v71, v9, v45
    v_dot2_f32_bf16 v46, v75, v9, v46
    v_dot2_f32_bf16 v47, v79, v9, v47
    s_waitcnt vmcnt(0)
    v_dot2_f32_bf16 v48, v80, v6, 0
    v_dot2_f32_bf16 v49, v84, v6, 0
    v_dot2_f32_bf16 v50, v88, v6, 0
    v_dot2_f32_bf16 v51, v92, v6, 0
    v_dot2_f32_bf16 v48, v81, v7, v48
    v_dot2_f32_bf16 v49, v85, v7, v49
    v_dot2_f32_bf16 v50, v89, v7, v50
    v_dot2_f32_bf16 v51, v93, v7, v51
    v_dot2_f32_bf16 v48, v82, v8, v48
    v_dot2_f32_bf16 v49, v86, v8, v49
    v_dot2_f32_bf16 v50, v90, v8, v50
    v_dot2_f32_bf16 v51, v94, v8, v51
    v_dot2_f32_bf16 v48, v83, v9, v48
    v_dot2_f32_bf16 v49, v87, v9, v49
    v_dot2_f32_bf16 v50, v91, v9, v50
    v_dot2_f32_bf16 v51, v95, v9, v51
    buffer_load_dwordx4 v[64:67], v2, s[64:67], s90 offen offset:0 nt
    buffer_load_dwordx4 v[68:71], v2, s[64:67], s90 offen offset:1024 nt
    buffer_load_dwordx4 v[72:75], v2, s[64:67], s90 offen offset:2048 nt
    buffer_load_dwordx4 v[76:79], v2, s[64:67], s90 offen offset:3072 nt
    buffer_load_dwordx4 v[80:83], v2, s[64:67], s91 offen offset:0 nt
    buffer_load_dwordx4 v[84:87], v2, s[64:67], s91 offen offset:1024 nt
    buffer_load_dwordx4 v[88:91], v2, s[64:67], s91 offen offset:2048 nt
    buffer_load_dwordx4 v[92:95], v2, s[64:67], s91 offen offset:3072 nt
    v_permlane16_swap_b32 v44, v45
    v_permlane16_swap_b32 v46, v47
    v_permlane16_swap_b32 v48, v49
    v_permlane16_swap_b32 v50, v51
    v_add_f32 v44, v44, v45
    v_add_f32 v46, v46, v47
    v_add_f32 v48, v48, v49
    v_add_f32 v50, v50, v51
    v_add_f32_dpp v45, v44, v44 row_ror:8 row_mask:0xf bank_mask:0x3
    v_add_f32_dpp v47, v48, v48 row_ror:8 row_mask:0xf bank_mask:0x3
    s_nop 0
    v_add_f32_dpp v45, v46, v46 row_ror:8 row_mask:0xf bank_mask:0xc
    v_add_f32_dpp v47, v50, v50 row_ror:8 row_mask:0xf bank_mask:0xc
    s_nop 0
    v_add_f32_dpp v44, v45, v45 row_half_mirror row_mask:0xf bank_mask:0x5
    s_nop 1
    v_add_f32_dpp v44, v47, v47 row_half_mirror row_mask:0xf bank_mask:0xa
    s_nop 1
    v_add_f32_dpp v44, v44, v44 quad_perm:[1,0,3,2] row_mask:0xf bank_mask:0xf
    s_nop 1
    v_add_f32_dpp v44, v44, v44 quad_perm:[2,3,0,1] row_mask:0xf bank_mask:0xf
    ds_write_b32 v52, v44 offset:2048
    s_mov_b32 s92, s93
    s_branch L_T01
L_hret:
    v_mov_b32 v58, 1
    s_lshl_b32 s8, s8, 8
    s_add_u32 s8, s8, 49152
    s_cmp_lg_u32 s26, 0
    s_cbranch_scc1 L_noini
    v_lshrrev_b32 v44, 2, v1
    v_mul_u32_u24 v44, 256, v44
    v_and_b32 v45, 3, v1
    v_lshl_add_u32 v44, v45, 4, v44
    v_mov_b32 v64, 0
    v_mov_b32 v65, 314048512
    v_mov_b32 v66, 0
    v_mov_b32 v67, v65
    s_sub_u32 s63, s60, 12288
    buffer_store_dwordx4 v[64:67], v44, s[80:83], s63 offen sc1
    s_sub_u32 s63, s60, 8192
    buffer_store_dwordx4 v[64:67], v44, s[80:83], s63 offen sc1
    s_sub_u32 s63, s60, 4096
    buffer_store_dwordx4 v[64:67], v44, s[80:83], s63 offen sc1
    s_sub_u32 s63, s60, 0
    buffer_store_dwordx4 v[64:67], v44, s[80:83], s63 offen sc1
    v_bfi_b32 v68, v251, s56, v64
    v_bfi_b32 v69, v251, s57, v65
    v_bfi_b32 v70, v251, s58, v66
    v_bfi_b32 v71, v251, s59, v67
    s_waitcnt vmcnt(0)
    buffer_store_dwordx4 v[68:71], v254, s[80:83], s8 offen sc1
L_noini:
    s_mul_i32 s35, s4, 3
    s_mul_i32 s7, s5, 4
    s_add_u32 s35, s35, s7
    s_sub_u32 s35, s35, 2
    s_lshl_b32 s7, s35, 7
    v_mov_b32 v49, 0x40000000
    v_subrev_u32 v14, s7, v2
    v_and_b32 v14, 0x7ff, v14
    v_cmp_gt_u32 vcc, 256, v14
    s_nop 1
    v_cndmask_b32 v14, v49, v14, vcc
    v_subrev_u32 v15, s7, v2
    v_xor_b32 v15, 0x400, v15
    v_and_b32 v15, 0x7ff, v15
    v_cmp_gt_u32 vcc, 256, v15
    s_nop 1
    v_cndmask_b32 v15, v49, v15, vcc
    s_lshl_b32 s36, s4, 2
    s_add_u32 s36, s36, s5
    s_lshl_b32 s36, s36, 12
    s_add_u32 s36, s36, 1114112
    s_lshl_b32 s37, s6, 9
    s_add_u32 s37, s37, s36
    s_lshl_b32 s63, s29, 13
    s_add_u32 s36, s36, s63
    v_and_b32 v45, 7, v1
    v_lshlrev_b32 v57, 4, v45
    s_lshl_b32 s100, s4, 10
    s_lshl_b32 s63, s5, 8
    s_add_u32 s100, s100, s63
    s_add_u32 s100, s100, 4096
    s_lshl_b32 s101, s6, 4
    s_add_u32 s101, s101, s100
    s_and_b32 s91, s2, 7
    s_lshl_b32 s91, s91, 8
    s_add_u32 s91, s91, 32768
    s_lshr_b32 s13, s2, 3
    s_lshl_b32 s21, s13, 2
    s_add_u32 s21, s21, s91
    s_mov_b32 s98, 0
    v_and_b32 v61, 31, v1
    v_lshlrev_b32 v61, 2, v61
    s_mov_b32 s20, 0
    s_mov_b32 s19, 96
    s_and_b32 s63, s2, 7
    s_mul_i32 s10, s63, 256
    s_add_u32 s10, s10, 40960
    v_mul_u32_u24 v51, 256, v45
    v_mov_b32 v44, 0x40000000
    v_cmp_eq_u32 vcc, s63, v45
    s_nop 1
    v_cndmask_b32 v51, v51, v44, vcc
    v_cmp_lt_u32 vcc, 7, v1
    s_nop 1
    v_cndmask_b32 v51, v51, v44, vcc
    s_mov_b32 s12, 40960
    v_mov_b32 v12, 0
    v_mov_b32 v13, -20
    s_mov_b32 s93, 0x1000000
    v_mov_b32 v10, 0x3db8aa3b
    v_mov_b32 v11, 0xffff0000
    s_mov_b32 s24, 38
    s_cmp_eq_u32 s31, 3
    s_cselect_b32 s34, -11, -7
L_svc:
    ds_read_b32 v55, v56
    s_sub_u32 s93, s93, 32
    s_waitcnt lgkmcnt(0)
    v_readfirstlane_b32 s23, v55
    s_cmp_le_i32 s93, 0
    s_cbranch_scc1 L_svcx
    s_and_b32 s23, s23, 0xff
    s_cmp_ge_u32 s23, s24
    s_cbranch_scc1 L_svcx
    s_lshl_b32 s22, s23, 12
    s_or_b32 s92, s22, s88
    s_or_b32 s92, s92, s20
    v_mov_b32 v60, s92
    buffer_store_dword v60, v254, s[80:83], s21 offen
    buffer_load_dword v59, v61, s[80:83], s91 offen sc1
    s_cmp_lg_u32 s13, 7
    s_cbranch_scc1 L_svcg
    buffer_load_dword v50, v51, s[80:83], s12 offen sc1
L_svcg:
    s_sub_u32 s22, s22, 8192
    v_mov_b32 v48, s22
    s_waitcnt vmcnt(0)
    v_xor_b32 v59, s88, v59
    v_and_b32 v49, v251, v59
    v_cmp_eq_u32 vcc, 0, v49
    s_nop 1
    v_cndmask_b32 v59, v48, v59, vcc
    s_nop 0
    v_readlane_b32 s11, v59, 7
    v_and_b32 v59, 0xff000, v59
    s_nop 1
    v_add_u32_dpp v59, v59, v59 quad_perm:[1,0,3,2] row_mask:0xf bank_mask:0xf
    s_nop 1
    v_add_u32_dpp v59, v59, v59 quad_perm:[2,3,0,1] row_mask:0xf bank_mask:0xf
    s_nop 1
    v_add_u32_dpp v59, v59, v59 row_half_mirror row_mask:0xf bank_mask:0xf
    s_nop 1
    v_add_u32_dpp v59, v59, v59 row_ror:8 row_mask:0xf bank_mask:0xf
    s_nop 1
    v_add_u32_dpp v59, v59, v59 row_bcast:15 row_mask:0xa bank_mask:0xf
    s_nop 0
    v_readlane_b32 s92, v59, 31
    s_nop 0
    s_lshr_b32 s92, s92, 15
    s_cmp_lg_u32 s13, 7
    s_cbranch_scc1 L_svch
    s_cmp_lt_u32 s92, s19
    s_cbranch_scc1 L_svcn
    s_add_u32 s19, s19, 56
    s_cmp_gt_u32 s19, 448
    s_cselect_b32 s19, 0x1000, s19
    s_lshl_b32 s63, s92, 12
    s_or_b32 s63, s63, s59
    v_mov_b32 v46, s63
    buffer_store_dword v46, v254, s[80:83], s10 offen sc1
L_svcn:
    v_xor_b32 v50, s59, v50
    v_and_b32 v49, 0xffc00fff, v50
    v_cmp_eq_u32 vcc, 0, v49
    s_nop 1
    v_cndmask_b32 v50, v12, v50, vcc
    v_cmp_ne_u32 vcc, v50, v12
    v_mov_b32 v12, v50
    v_lshrrev_b32 v49, 12, v50
    v_subrev_u32 v49, s92, v49
    v_cndmask_b32 v13, v13, v49, vcc
    s_nop 1
    v_add_u32_dpp v50, v13, v13 quad_perm:[1,0,3,2] row_mask:0xf bank_mask:0xf
    s_nop 1
    v_add_u32_dpp v50, v50, v50 quad_perm:[2,3,0,1] row_mask:0xf bank_mask:0xf
    s_nop 1
    v_add_u32_dpp v50, v50, v50 row_half_mirror row_mask:0xf bank_mask:0xf
    s_nop 0
    v_readfirstlane_b32 s63, v50
    s_nop 0
    s_sub_i32 s63, s63, -160
    s_mul_i32 s63, s63, 16
    s_ashr_i32 s63, s63, 7
    s_max_i32 s63, s63, -4
    s_min_i32 s63, s63, 12
    s_lshl_b32 s20, s63, 20
L_svch:
    s_ashr_i32 s11, s11, 20
    s_add_i32 s92, s92, s11
    s_lshl_b32 s63, s23, 2
    s_sub_i32 s92, s92, s63
    s_sub_i32 s92, s92, s34
    s_mul_i32 s92, s92, 12
    s_ashr_i32 s92, s92, 4
    s_min_i32 s92, s92, 24
    s_add_u32 s63, s23, 3
    s_add_u32 s63, s63, s92
    s_lshl_b32 s63, s63, 24
    s_cmp_gt_i32 s92, 0
    s_cselect_b32 s92, s63, 0
    s_sub_u32 s63, s92, s98
    s_mov_b32 s98, s92
    v_mov_b32 v55, s63
    s_mov_b64 exec, 1
    ds_add_u32 v56, v55
    s_mov_b64 exec, -1
    s_branch L_svc
L_svcx:
    s_cmp_eq_u32 s24, 38
    s_cbranch_scc1 L_sp0
    s_cmp_eq_u32 s24, 48
    s_cbranch_scc1 L_md0
    s_cmp_eq_u32 s24, 70
    s_cbranch_scc1 L_sp1
    s_cmp_eq_u32 s24, 80
    s_cbranch_scc1 L_md1
    s_cmp_eq_u32 s24, 86
    s_cbranch_scc1 L_lp
L_w1:
    ds_read_b32 v55, v56
    s_sub_u32 s93, s93, 1
    s_waitcnt lgkmcnt(0)
    v_readfirstlane_b32 s92, v55
    s_cmp_le_i32 s93, 0
    s_cbranch_scc1 L_w1x
    s_and_b32 s92, s92, 0xff
    s_cmp_lt_u32 s92, 128
    s_cbranch_scc1 L_w1
L_w1x:
    buffer_load_dwordx4 v[224:227], v62, s[80:83], s30 offen offset:0 sc1
    buffer_load_dwordx4 v[228:231], v62, s[80:83], s30 offen offset:1024 sc1
    buffer_load_dwordx4 v[160:163], v250, s[76:79], s14 offen offset:0
    buffer_load_dwordx4 v[164:167], v250, s[76:79], s14 offen offset:1792
    buffer_load_dwordx4 v[168:171], v250, s[76:79], s15 offen offset:0
    buffer_load_dwordx4 v[172:175], v250, s[76:79], s15 offen offset:1792
    buffer_load_dwordx4 v[176:179], v250, s[76:79], s16 offen offset:0
    buffer_load_dwordx4 v[180:183], v250, s[76:79], s16 offen offset:1792
    buffer_load_dwordx4 v[184:187], v250, s[76:79], s17 offen offset:0
    buffer_load_dwordx4 v[188:191], v250, s[76:79], s17 offen offset:1792
    buffer_load_dwordx4 v[192:195], v250, s[76:79], s14 offen offset:896
    buffer_load_dwordx4 v[196:199], v250, s[76:79], s14 offen offset:2688
    buffer_load_dwordx4 v[200:203], v250, s[76:79], s15 offen offset:896
    buffer_load_dwordx4 v[204:207], v250, s[76:79], s15 offen offset:2688
    buffer_load_dwordx4 v[208:211], v250, s[76:79], s16 offen offset:896
    buffer_load_dwordx4 v[212:215], v250, s[76:79], s16 offen offset:2688
    buffer_load_dwordx4 v[216:219], v250, s[76:79], s17 offen offset:896
    buffer_load_dwordx4 v[220:223], v250, s[76:79], s17 offen offset:2688
    s_add_u32 s31, s30, 1376256
    s_waitcnt vmcnt(16)
    s_branch L_echk
L_epoll:
    buffer_load_dwordx4 v[224:227], v62, s[80:83], s30 offen offset:0 sc1
    buffer_load_dwordx4 v[228:231], v62, s[80:83], s30 offen offset:1024 sc1
    s_waitcnt vmcnt(0)
L_echk:
    s_sub_u32 s61, s61, 1
    v_xor_b32 v224, s56, v224
    v_xor_b32 v225, s57, v225
    v_xor_b32 v226, s58, v226
    v_xor_b32 v227, s88, v227
    v_xor_b32 v228, s56, v228
    v_xor_b32 v229, s57, v229
    v_xor_b32 v230, s58, v230
    v_xor_b32 v231, s88, v231
    v_or3_b32 v48, v224, v225, v226
    v_or3_b32 v48, v48, v227, v228
    v_or3_b32 v48, v48, v229, v230
    v_or_b32 v48, v48, v231
    v_and_b32 v48, v251, v48
    v_cmp_ne_u32 vcc, 0, v48
    s_nop 0
    s_cbranch_vccz L_ego
    s_cmp_le_i32 s61, 0
    s_cbranch_scc1 L_ego
    s_cmp_eq_u32 s99, 0
    s_cbranch_scc1 L_epoll
    buffer_load_dwordx4 v[224:227], v62, s[80:83], s31 offen offset:0 sc1
    buffer_load_dwordx4 v[228:231], v62, s[80:83], s31 offen offset:1024 sc1
    s_waitcnt vmcnt(0)
    v_xor_b32 v224, s56, v224
    v_xor_b32 v225, s57, v225
    v_xor_b32 v226, s58, v226
    v_xor_b32 v227, s59, v227
    v_xor_b32 v228, s56, v228
    v_xor_b32 v229, s57, v229
    v_xor_b32 v230, s58, v230
    v_xor_b32 v231, s59, v231
    v_or3_b32 v48, v224, v225, v226
    v_or3_b32 v48, v48, v227, v228
    v_or3_b32 v48, v48, v229, v230
    v_or_b32 v48, v48, v231
    v_and_b32 v48, v251, v48
    v_cmp_ne_u32 vcc, 0, v48
    s_nop 0
    s_cbranch_vccnz L_epoll
L_ego:
    v_permlane32_swap_b32 v224, v228
    v_permlane32_swap_b32 v225, v229
    v_permlane32_swap_b32 v226, v230
    v_permlane32_swap_b32 v227, v231
    v_add_f32 v224, v224, v228
    v_add_f32 v225, v225, v229
    v_add_f32 v226, v226, v230
    v_add_f32 v227, v227, v231
    v_add_f32_dpp v28, v224, v224 row_ror:8 row_mask:0xf bank_mask:0xf
    v_add_f32_dpp v29, v225, v225 row_ror:8 row_mask:0xf bank_mask:0xf
    v_add_f32_dpp v30, v226, v226 row_ror:8 row_mask:0xf bank_mask:0xf
    v_add_f32_dpp v31, v227, v227 row_ror:8 row_mask:0xf bank_mask:0xf
    s_branch L_sum
L_lp:
    v_lshrrev_b32 v44, 3, v1
    v_lshlrev_b32 v44, 4, v44
    v_lshl_add_u32 v45, v57, 5, v44
    v_lshl_add_u32 v44, v57, 3, v44
    s_add_u32 s63, s36, 1376256
L_lpoll:
    s_sub_u32 s61, s61, 1
    buffer_load_dwordx4 v[64:67], v45, s[80:83], s36 offen offset:0 sc1
    buffer_load_dwordx4 v[68:71], v45, s[80:83], s36 offen offset:128 sc1
    s_waitcnt vmcnt(0)
    v_xor_b32 v64, s56, v64
    v_xor_b32 v65, s57, v65
    v_xor_b32 v66, s58, v66
    v_xor_b32 v67, s88, v67
    v_xor_b32 v68, s56, v68
    v_xor_b32 v69, s57, v69
    v_xor_b32 v70, s58, v70
    v_xor_b32 v71, s88, v71
    v_or3_b32 v48, v64, v65, v66
    v_or3_b32 v48, v48, v67, v68
    v_or3_b32 v48, v48, v69, v70
    v_or_b32 v48, v48, v71
    v_and_b32 v48, v251, v48
    v_cmp_ne_u32 vcc, 0, v48
    s_nop 0
    s_cbranch_vccz L_lgo
    s_cmp_le_i32 s61, 0
    s_cbranch_scc1 L_lgo
    s_cmp_eq_u32 s99, 0
    s_cbranch_scc1 L_lpoll
    buffer_load_dwordx4 v[64:67], v45, s[80:83], s63 offen offset:0 sc1
    buffer_load_dwordx4 v[68:71], v45, s[80:83], s63 offen offset:128 sc1
    s_waitcnt vmcnt(0)
    v_xor_b32 v64, s56, v64
    v_xor_b32 v65, s57, v65
    v_xor_b32 v66, s58, v66
    v_xor_b32 v67, s59, v67
    v_xor_b32 v68, s56, v68
    v_xor_b32 v69, s57, v69
    v_xor_b32 v70, s58, v70
    v_xor_b32 v71, s59, v71
    v_or3_b32 v48, v64, v65, v66
    v_or3_b32 v48, v48, v67, v68
    v_or3_b32 v48, v48, v69, v70
    v_or_b32 v48, v48, v71
    v_and_b32 v48, v251, v48
    v_cmp_ne_u32 vcc, 0, v48
    s_nop 0
    s_cbranch_vccnz L_lpoll
L_lgo:
    buffer_load_dwordx4 v[80:83], off, s[80:83], s8 sc1
    s_sub_u32 s61, s61, 1
    s_waitcnt vmcnt(0)
    v_xor_b32 v80, s56, v80
    v_xor_b32 v81, s57, v81
    v_xor_b32 v82, s58, v82
    v_xor_b32 v83, s59, v83
    v_or3_b32 v48, v80, v81, v82
    v_or_b32 v48, v48, v83
    v_and_b32 v48, v251, v48
    v_cmp_ne_u32 vcc, 0, v48
    s_cmp_le_i32 s61, 0
    s_cbranch_scc1 L_lgo2
    s_cbranch_vccnz L_lgo
L_lgo2:
    v_mul_f32 v64, v16, v64
    v_mul_f32 v65, v16, v65
    v_mul_f32 v66, v16, v66
    v_mul_f32 v67, v16, v67
    v_mul_f32 v68, v16, v68
    v_mul_f32 v69, v16, v69
    v_mul_f32 v70, v16, v70
    v_mul_f32 v71, v16, v71
    v_cvt_pk_bf16_f32 v64, v64, v64
    v_cvt_pk_bf16_f32 v65, v65, v65
    v_cvt_pk_bf16_f32 v66, v66, v66
    v_cvt_pk_bf16_f32 v67, v67, v67
    v_cvt_pk_bf16_f32 v68, v68, v68
    v_cvt_pk_bf16_f32 v69, v69, v69
    v_cvt_pk_bf16_f32 v70, v70, v70
    v_cvt_pk_bf16_f32 v71, v71, v71
    s_add_u32 s63, s35, 0
    s_and_b32 s63, s63, 3
    s_lshl_b32 s63, s63, 10
    v_add_u32 v45, s63, v44
    ds_write_b128 v45, v[64:67] offset:14336
    s_add_u32 s63, s35, 1
    s_and_b32 s63, s63, 3
    s_lshl_b32 s63, s63, 10
    v_add_u32 v45, s63, v44
    ds_write_b128 v45, v[68:71] offset:14336
    v_mov_b32 v55, 65536
    s_mov_b64 exec, 1
    ds_add_u32 v56, v55
    s_mov_b64 exec, -1
    s_mov_b32 s24, 124
    s_branch L_svc
L_sp0:
    ds_read_b128 v[64:67], v2 offset:2048
    ds_read_b128 v[68:71], v2 offset:3072
    s_sub_u32 s93, s93, 1
    s_waitcnt lgkmcnt(0)
    v_max3_u32 v48, v64, v65, v66
    v_max3_u32 v49, v67, v68, v69
    v_max3_u32 v48, v48, v70, v71
    v_max_u32 v48, v48, v49
    v_cmp_eq_u32 vcc, -1, v48
    v_max3_f32 v48, v64, v65, v66
    v_max3_f32 v49, v67, v68, v69
    v_max3_f32 v48, v48, v70, v71
    s_cmp_le_i32 s93, 0
    s_cbranch_scc1 L_spx0
    s_cbranch_vccnz L_sp0
L_spx0:
    v_max_f32 v48, v48, v49
    s_nop 1
    v_max_f32_dpp v48, v48, v48 quad_perm:[1,0,3,2] row_mask:0xf bank_mask:0xf
    s_nop 1
    v_max_f32_dpp v48, v48, v48 quad_perm:[2,3,0,1] row_mask:0xf bank_mask:0xf
    s_nop 1
    v_max_f32_dpp v48, v48, v48 row_half_mirror row_mask:0xf bank_mask:0xf
    s_nop 1
    v_max_f32_dpp v48, v48, v48 row_ror:8 row_mask:0xf bank_mask:0xf
    s_nop 1
    v_max_f32_dpp v48, v48, v48 row_bcast:15 row_mask:0xa bank_mask:0xf
    s_nop 1
    v_max_f32_dpp v48, v48, v48 row_bcast:31 row_mask:0xc bank_mask:0xf
    v_mul_f32 v48, v10, v48
    s_nop 0
    v_readlane_b32 s97, v48, 63
    s_nop 0
    s_andn2_b32 s97, s97, 0xfff
    v_fma_f32 v64, v64, v10, -s97
    v_fma_f32 v65, v65, v10, -s97
    v_fma_f32 v66, v66, v10, -s97
    v_fma_f32 v67, v67, v10, -s97
    v_fma_f32 v68, v68, v10, -s97
    v_fma_f32 v69, v69, v10, -s97
    v_fma_f32 v70, v70, v10, -s97
    v_fma_f32 v71, v71, v10, -s97
    v_exp_f32 v64, v64
    v_exp_f32 v65, v65
    v_exp_f32 v66, v66
    v_exp_f32 v67, v67
    v_exp_f32 v68, v68
    v_exp_f32 v69, v69
    v_exp_f32 v70, v70
    v_exp_f32 v71, v71
    v_bfi_b32 v72, v251, s56, v64
    v_bfi_b32 v73, v251, s57, v65
    v_bfi_b32 v74, v251, s58, v66
    v_bfi_b32 v75, v251, s88, v67
    v_bfi_b32 v76, v251, s56, v68
    v_bfi_b32 v77, v251, s57, v69
    v_bfi_b32 v78, v251, s58, v70
    v_bfi_b32 v79, v251, s88, v71
    v_cvt_pk_bf16_f32 v64, v64, v64
    v_cvt_pk_bf16_f32 v65, v65, v65
    v_cvt_pk_bf16_f32 v66, v66, v66
    v_cvt_pk_bf16_f32 v67, v67, v67
    v_cvt_pk_bf16_f32 v68, v68, v68
    v_cvt_pk_bf16_f32 v69, v69, v69
    v_cvt_pk_bf16_f32 v70, v70, v70
    v_cvt_pk_bf16_f32 v71, v71, v71
    ds_write_b128 v2, v[64:67] offset:2048
    ds_write_b128 v2, v[68:71] offset:3072
    v_mov_b32 v55, 262144
    s_mov_b64 exec, 1
    ds_add_u32 v56, v55
    s_mov_b64 exec, -1
    buffer_store_dwordx4 v[72:75], v14, s[80:83], s37 offen
    buffer_store_dwordx4 v[76:79], v15, s[80:83], s37 offen
    v_and_b32 v64, v11, v64
    v_and_b32 v65, v11, v65
    v_and_b32 v66, v11, v66
    v_and_b32 v67, v11, v67
    v_and_b32 v68, v11, v68
    v_and_b32 v69, v11, v69
    v_and_b32 v70, v11, v70
    v_and_b32 v71, v11, v71
    v_add_f32 v64, v64, v68
    v_add_f32 v65, v65, v69
    v_add_f32 v66, v66, v70
    v_add_f32 v67, v67, v71
    v_add_f32 v64, v64, v66
    v_add_f32 v65, v65, v67
    v_add_f32 v64, v64, v65
    s_nop 1
    v_add_f32_dpp v64, v64, v64 quad_perm:[1,0,3,2] row_mask:0xf bank_mask:0xf
    s_nop 1
    v_add_f32_dpp v64, v64, v64 quad_perm:[2,3,0,1] row_mask:0xf bank_mask:0xf
    s_nop 1
    v_add_f32_dpp v64, v64, v64 row_half_mirror row_mask:0xf bank_mask:0xf
    s_nop 1
    v_add_f32_dpp v64, v64, v64 row_ror:8 row_mask:0xf bank_mask:0xf
    s_nop 1
    v_add_f32_dpp v64, v64, v64 row_bcast:15 row_mask:0xa bank_mask:0xf
    s_nop 1
    v_add_f32_dpp v64, v64, v64 row_bcast:31 row_mask:0xc bank_mask:0xf
    s_nop 0
    v_readlane_b32 s96, v64, 63
    s_nop 0
    s_andn2_b32 s92, s96, 0xfff
    v_mov_b32 v44, s97
    v_mov_b32 v45, s92
    v_sub_f32 v46, s96, v45
    v_mov_b32 v47, 0
    v_bfi_b32 v44, v251, s56, v44
    v_bfi_b32 v45, v251, s57, v45
    v_bfi_b32 v46, v251, s58, v46
    v_bfi_b32 v47, v251, s88, v47
    buffer_store_dwordx4 v[44:47], v254, s[80:83], s101 offen offset:0
    s_mov_b32 s24, 48
    s_cmp_eq_u32 s99, 0
    s_cbranch_scc1 L_svc
    v_bfi_b32 v44, v251, s56, v44
    v_bfi_b32 v45, v251, s57, v45
    v_bfi_b32 v46, v251, s58, v46
    v_bfi_b32 v47, v251, s59, v47
    s_add_u32 s63, s101, 1376256
    buffer_store_dwordx4 v[44:47], v254, s[80:83], s63 offen offset:0 sc1
    v_bfi_b32 v72, v251, s56, v72
    v_bfi_b32 v73, v251, s57, v73
    v_bfi_b32 v74, v251, s58, v74
    v_bfi_b32 v75, v251, s59, v75
    v_bfi_b32 v76, v251, s56, v76
    v_bfi_b32 v77, v251, s57, v77
    v_bfi_b32 v78, v251, s58, v78
    v_bfi_b32 v79, v251, s59, v79
    s_add_u32 s63, s37, 1376256
    buffer_store_dwordx4 v[72:75], v14, s[80:83], s63 offen sc1
    buffer_store_dwordx4 v[76:79], v15, s[80:83], s63 offen sc1
    s_branch L_svc
L_md0:
    s_add_u32 s63, s100, 1376256
L_mpoll0:
    buffer_load_dwordx4 v[64:67], v57, s[80:83], s100 offen offset:0 sc1
    s_sub_u32 s61, s61, 1
    s_waitcnt vmcnt(0)
    v_xor_b32 v64, s56, v64
    v_xor_b32 v65, s57, v65
    v_xor_b32 v66, s58, v66
    v_xor_b32 v67, s88, v67
    v_or3_b32 v48, v64, v65, v66
    v_or_b32 v48, v48, v67
    v_and_b32 v48, v251, v48
    v_cmp_ne_u32 vcc, 0, v48
    s_nop 0
    s_cbranch_vccz L_mgo0
    s_cmp_le_i32 s61, 0
    s_cbranch_scc1 L_mgo0
    s_cmp_eq_u32 s99, 0
    s_cbranch_scc1 L_mpoll0
    buffer_load_dwordx4 v[64:67], v57, s[80:83], s63 offen offset:0 sc1
    s_waitcnt vmcnt(0)
    v_xor_b32 v64, s56, v64
    v_xor_b32 v65, s57, v65
    v_xor_b32 v66, s58, v66
    v_xor_b32 v67, s59, v67
    v_or3_b32 v48, v64, v65, v66
    v_or_b32 v48, v48, v67
    v_and_b32 v48, v251, v48
    v_cmp_ne_u32 vcc, 0, v48
    s_nop 0
    s_cbranch_vccnz L_mpoll0
L_mgo0:
    v_max_f32_dpp v48, v64, v64 quad_perm:[1,0,3,2] row_mask:0xf bank_mask:0xf
    v_add_f32 v65, v65, v66
    s_nop 0
    v_max_f32_dpp v48, v48, v48 quad_perm:[2,3,0,1] row_mask:0xf bank_mask:0xf
    s_nop 1
    v_max_f32_dpp v48, v48, v48 row_half_mirror row_mask:0xf bank_mask:0xf
    v_sub_f32 v49, v64, v48
    v_sub_f32 v48, s97, v48
    v_exp_f32 v47, v49
    v_exp_f32 v48, v48
    v_mul_f32 v49, v47, v65
    s_nop 1
    v_add_f32_dpp v49, v49, v49 quad_perm:[1,0,3,2] row_mask:0xf bank_mask:0xf
    s_nop 1
    v_add_f32_dpp v49, v49, v49 quad_perm:[2,3,0,1] row_mask:0xf bank_mask:0xf
    s_nop 1
    v_add_f32_dpp v49, v49, v49 row_half_mirror row_mask:0xf bank_mask:0xf
    v_rcp_f32 v49, v49
    s_nop 0
    v_mul_f32 v48, v48, v49
    v_mul_f32 v16, v47, v49
    s_mov_b64 exec, 1
    ds_write_b32 v56, v48 offset:16
    s_mov_b64 exec, -1
    v_mov_b32 v55, 2097152
    s_mov_b64 exec, 1
    ds_add_u32 v56, v55
    s_mov_b64 exec, -1
    s_mov_b32 s24, 70
    s_branch L_svc
L_sp1:
    ds_read_b128 v[64:67], v2 offset:4096
    ds_read_b128 v[68:71], v2 offset:5120
    s_sub_u32 s93, s93, 1
    s_waitcnt lgkmcnt(0)
    v_max3_u32 v48, v64, v65, v66
    v_max3_u32 v49, v67, v68, v69
    v_max3_u32 v48, v48, v70, v71
    v_max_u32 v48, v48, v49
    v_cmp_eq_u32 vcc, -1, v48
    v_max3_f32 v48, v64, v65, v66
    v_max3_f32 v49, v67, v68, v69
    v_max3_f32 v48, v48, v70, v71
    s_cmp_le_i32 s93, 0
    s_cbranch_scc1 L_spx1
    s_cbranch_vccnz L_sp1
L_spx1:
    v_max_f32 v48, v48, v49
    s_nop 1
    v_max_f32_dpp v48, v48, v48 quad_perm:[1,0,3,2] row_mask:0xf bank_mask:0xf
    s_nop 1
    v_max_f32_dpp v48, v48, v48 quad_perm:[2,3,0,1] row_mask:0xf bank_mask:0xf
    s_nop 1
    v_max_f32_dpp v48, v48, v48 row_half_mirror row_mask:0xf bank_mask:0xf
    s_nop 1
    v_max_f32_dpp v48, v48, v48 row_ror:8 row_mask:0xf bank_mask:0xf
    s_nop 1
    v_max_f32_dpp v48, v48, v48 row_bcast:15 row_mask:0xa bank_mask:0xf
    s_nop 1
    v_max_f32_dpp v48, v48, v48 row_bcast:31 row_mask:0xc bank_mask:0xf
    v_mul_f32 v48, v10, v48
    s_nop 0
    v_readlane_b32 s97, v48, 63
    s_nop 0
    s_andn2_b32 s97, s97, 0xfff
    v_fma_f32 v64, v64, v10, -s97
    v_fma_f32 v65, v65, v10, -s97
    v_fma_f32 v66, v66, v10, -s97
    v_fma_f32 v67, v67, v10, -s97
    v_fma_f32 v68, v68, v10, -s97
    v_fma_f32 v69, v69, v10, -s97
    v_fma_f32 v70, v70, v10, -s97
    v_fma_f32 v71, v71, v10, -s97
    v_exp_f32 v64, v64
    v_exp_f32 v65, v65
    v_exp_f32 v66, v66
    v_exp_f32 v67, v67
    v_exp_f32 v68, v68
    v_exp_f32 v69, v69
    v_exp_f32 v70, v70
    v_exp_f32 v71, v71
    v_bfi_b32 v72, v251, s56, v64
    v_bfi_b32 v73, v251, s57, v65
    v_bfi_b32 v74, v251, s58, v66
    v_bfi_b32 v75, v251, s88, v67
    v_bfi_b32 v76, v251, s56, v68
    v_bfi_b32 v77, v251, s57, v69
    v_bfi_b32 v78, v251, s58, v70
    v_bfi_b32 v79, v251, s88, v71
    v_cvt_pk_bf16_f32 v64, v64, v64
    v_cvt_pk_bf16_f32 v65, v65, v65
    v_cvt_pk_bf16_f32 v66, v66, v66
    v_cvt_pk_bf16_f32 v67, v67, v67
    v_cvt_pk_bf16_f32 v68, v68, v68
    v_cvt_pk_bf16_f32 v69, v69, v69
    v_cvt_pk_bf16_f32 v70, v70, v70
    v_cvt_pk_bf16_f32 v71, v71, v71
    ds_write_b128 v2, v[64:67] offset:4096
    ds_write_b128 v2, v[68:71] offset:5120
    v_mov_b32 v55, 4194304
    s_mov_b64 exec, 1
    ds_add_u32 v56, v55
    s_mov_b64 exec, -1
    s_add_u32 s37, s37, 0x2000
    buffer_store_dwordx4 v[72:75], v14, s[80:83], s37 offen
    buffer_store_dwordx4 v[76:79], v15, s[80:83], s37 offen
    v_and_b32 v64, v11, v64
    v_and_b32 v65, v11, v65
    v_and_b32 v66, v11, v66
    v_and_b32 v67, v11, v67
    v_and_b32 v68, v11, v68
    v_and_b32 v69, v11, v69
    v_and_b32 v70, v11, v70
    v_and_b32 v71, v11, v71
    v_add_f32 v64, v64, v68
    v_add_f32 v65, v65, v69
    v_add_f32 v66, v66, v70
    v_add_f32 v67, v67, v71
    v_add_f32 v64, v64, v66
    v_add_f32 v65, v65, v67
    v_add_f32 v64, v64, v65
    s_nop 1
    v_add_f32_dpp v64, v64, v64 quad_perm:[1,0,3,2] row_mask:0xf bank_mask:0xf
    s_nop 1
    v_add_f32_dpp v64, v64, v64 quad_perm:[2,3,0,1] row_mask:0xf bank_mask:0xf
    s_nop 1
    v_add_f32_dpp v64, v64, v64 row_half_mirror row_mask:0xf bank_mask:0xf
    s_nop 1
    v_add_f32_dpp v64, v64, v64 row_ror:8 row_mask:0xf bank_mask:0xf
    s_nop 1
    v_add_f32_dpp v64, v64, v64 row_bcast:15 row_mask:0xa bank_mask:0xf
    s_nop 1
    v_add_f32_dpp v64, v64, v64 row_bcast:31 row_mask:0xc bank_mask:0xf
    s_nop 0
    v_readlane_b32 s96, v64, 63
    s_nop 0
    s_andn2_b32 s92, s96, 0xfff
    v_mov_b32 v44, s97
    v_mov_b32 v45, s92
    v_sub_f32 v46, s96, v45
    v_mov_b32 v47, 0
    v_bfi_b32 v44, v251, s56, v44
    v_bfi_b32 v45, v251, s57, v45
    v_bfi_b32 v46, v251, s58, v46
    v_bfi_b32 v47, v251, s88, v47
    buffer_store_dwordx4 v[44:47], v254, s[80:83], s101 offen offset:512
    s_mov_b32 s24, 80
    s_cmp_eq_u32 s99, 0
    s_cbranch_scc1 L_svc
    v_bfi_b32 v44, v251, s56, v44
    v_bfi_b32 v45, v251, s57, v45
    v_bfi_b32 v46, v251, s58, v46
    v_bfi_b32 v47, v251, s59, v47
    s_add_u32 s63, s101, 1376256
    buffer_store_dwordx4 v[44:47], v254, s[80:83], s63 offen offset:512 sc1
    v_bfi_b32 v72, v251, s56, v72
    v_bfi_b32 v73, v251, s57, v73
    v_bfi_b32 v74, v251, s58, v74
    v_bfi_b32 v75, v251, s59, v75
    v_bfi_b32 v76, v251, s56, v76
    v_bfi_b32 v77, v251, s57, v77
    v_bfi_b32 v78, v251, s58, v78
    v_bfi_b32 v79, v251, s59, v79
    s_add_u32 s63, s37, 1376256
    buffer_store_dwordx4 v[72:75], v14, s[80:83], s63 offen sc1
    buffer_store_dwordx4 v[76:79], v15, s[80:83], s63 offen sc1
    s_branch L_svc
L_md1:
    s_add_u32 s63, s100, 1376256
L_mpoll1:
    buffer_load_dwordx4 v[64:67], v57, s[80:83], s100 offen offset:512 sc1
    s_sub_u32 s61, s61, 1
    s_waitcnt vmcnt(0)
    v_xor_b32 v64, s56, v64
    v_xor_b32 v65, s57, v65
    v_xor_b32 v66, s58, v66
    v_xor_b32 v67, s88, v67
    v_or3_b32 v48, v64, v65, v66
    v_or_b32 v48, v48, v67
    v_and_b32 v48, v251, v48
    v_cmp_ne_u32 vcc, 0, v48
    s_nop 0
    s_cbranch_vccz L_mgo1
    s_cmp_le_i32 s61, 0
    s_cbranch_scc1 L_mgo1
    s_cmp_eq_u32 s99, 0
    s_cbranch_scc1 L_mpoll1
    buffer_load_dwordx4 v[64:67], v57, s[80:83], s63 offen offset:512 sc1
    s_waitcnt vmcnt(0)
    v_xor_b32 v64, s56, v64
    v_xor_b32 v65, s57, v65
    v_xor_b32 v66, s58, v66
    v_xor_b32 v67, s59, v67
    v_or3_b32 v48, v64, v65, v66
    v_or_b32 v48, v48, v67
    v_and_b32 v48, v251, v48
    v_cmp_ne_u32 vcc, 0, v48
    s_nop 0
    s_cbranch_vccnz L_mpoll1
L_mgo1:
    v_max_f32_dpp v48, v64, v64 quad_perm:[1,0,3,2] row_mask:0xf bank_mask:0xf
    v_add_f32 v65, v65, v66
    s_nop 0
    v_max_f32_dpp v48, v48, v48 quad_perm:[2,3,0,1] row_mask:0xf bank_mask:0xf
    s_nop 1
    v_max_f32_dpp v48, v48, v48 row_half_mirror row_mask:0xf bank_mask:0xf
    v_sub_f32 v49, v64, v48
    v_sub_f32 v48, s97, v48
    v_exp_f32 v47, v49
    v_exp_f32 v48, v48
    v_mul_f32 v49, v47, v65
    s_nop 1
    v_add_f32_dpp v49, v49, v49 quad_perm:[1,0,3,2] row_mask:0xf bank_mask:0xf
    s_nop 1
    v_add_f32_dpp v49, v49, v49 quad_perm:[2,3,0,1] row_mask:0xf bank_mask:0xf
    s_nop 1
    v_add_f32_dpp v49, v49, v49 row_half_mirror row_mask:0xf bank_mask:0xf
    v_rcp_f32 v49, v49
    s_cmp_eq_u32 s29, 1
    s_cselect_b64 vcc, -1, 0
    v_mul_f32 v48, v48, v49
    v_mul_f32 v47, v47, v49
    v_cndmask_b32 v16, v16, v47, vcc
    s_mov_b64 exec, 1
    ds_write_b32 v56, v48 offset:20
    s_mov_b64 exec, -1
    v_mov_b32 v55, 8388608
    s_mov_b64 exec, 1
    ds_add_u32 v56, v55
    s_mov_b64 exec, -1
    s_mov_b32 s24, 86
    s_branch L_svc
L_T01:
    s_cmp_eq_u32 s38, 64
    s_cbranch_scc1 L_T12
    s_mov_b32 s63, s36
L_wqb:
    s_bitcmp1_b32 s63, 19
    s_cbranch_scc1 L_wqbx
    ds_read_b32 v59, v56
    s_sub_u32 s39, s39, 1
    s_waitcnt lgkmcnt(0)
    v_readfirstlane_b32 s63, v59
    s_cmp_gt_i32 s39, 0
    s_cbranch_scc1 L_wqb
L_wqbx:
    ds_read_b128 v[6:9], v53 offset:512
    s_mov_b32 s38, 64
    v_add_u32 v10, 2048, v10
    s_waitcnt lgkmcnt(0)
    s_branch L_K0c
L_T12:
    s_mov_b32 s63, s36
L_wpa:
    s_bitcmp1_b32 s63, 18
    s_cbranch_scc1 L_wpax
    ds_read_b32 v59, v56
    s_sub_u32 s39, s39, 1
    s_waitcnt lgkmcnt(0)
    v_readfirstlane_b32 s63, v59
    s_cmp_gt_i32 s39, 0
    s_cbranch_scc1 L_wpa
L_wpax:
    ds_read_b64 v[50:51], v56 offset:24
    s_bfe_u32 s99, s63, 65556
    s_getreg_b32 s88, hwreg(HW_REG_XCC_ID, 0, 4)
    v_mov_b32 v251, 0xfff
    v_mov_b32 v44, 0x40000000
    v_cmp_eq_u32 vcc, 0, v1
    s_nop 1
    v_cndmask_b32 v254, v44, v2, vcc
    s_mov_b32 s61, 0x100000
    v_and_b32 v46, 1, v1
    v_lshlrev_b32 v46, 4, v46
    v_mov_b32 v47, 0xffff
    v_lshlrev_b32 v47, v46, v47
    v_lshrrev_b32 v44, 1, v1
    v_xor_b32 v45, v44, v1
    v_and_b32 v45, 8, v45
    v_and_b32 v44, 3, v44
    v_add_u32 v44, v44, v45
    v_cmp_eq_u32 vcc, 0, v44
    s_nop 1
    v_cndmask_b32 v14, 0, v47, vcc
    v_cmp_eq_u32 vcc, 1, v44
    s_nop 1
    v_cndmask_b32 v15, 0, v47, vcc
    v_cmp_eq_u32 vcc, 2, v44
    s_nop 1
    v_cndmask_b32 v16, 0, v47, vcc
    v_cmp_eq_u32 vcc, 3, v44
    s_nop 1
    v_cndmask_b32 v17, 0, v47, vcc
    v_mov_b32 v28, 0
    v_mov_b32 v29, 0
    v_mov_b32 v30, 0
    v_mov_b32 v31, 0
    s_waitcnt lgkmcnt(0)
    v_readfirstlane_b32 s94, v50
    v_readfirstlane_b32 s95, v51
    s_add_u32 s94, s94, 0x7f4a7c15
    s_addc_u32 s95, s95, 0x9e3779b9
    s_and_b32 s56, s94, 0xfff
    s_bfe_u32 s57, s94, 0xc000c
    s_lshr_b64 s[58:59], s[94:95], 24
    s_bfe_u32 s59, s58, 0xc000c
    s_and_b32 s58, s58, 0xfff
    s_add_u32 s88, s88, 1
    s_xor_b32 s88, s88, s59
    v_mov_b32 v3, v2
    v_mov_b32 v4, v2
    s_movk_i32 s68, 0x780
    s_movk_i32 s69, 0x40
    s_mov_b32 s70, 6
    s_movk_i32 s71, 0x7c0
    s_mov_b64 s[100:101], s[68:69]
    s_mov_b64 s[24:25], s[70:71]
    s_mov_b64 s[96:97], s[22:23]
    s_mov_b32 s74, s34
    s_add_u32 s75, s35, 4
    s_mov_b32 s38, 92
    s_movk_i32 s73, 256
L_tset:
    s_and_b32 s31, s6, 3
    s_lshr_b32 s29, s6, 2
    s_lshl_b32 s26, s4, 2
    s_add_u32 s26, s26, s31
    s_mul_i32 s14, s26, 57344
    s_lshl_b32 s15, s3, 8
    s_add_u32 s14, s14, s15
    s_add_u32 s15, s14, 7168
    s_add_u32 s16, s14, 14336
    s_add_u32 s17, s14, 21504
    v_mov_b32 v49, 0x40000000
    v_lshrrev_b32 v44, 4, v1
    v_and_b32 v45, 15, v1
    v_and_b32 v48, 7, v1
    v_lshrrev_b32 v50, 5, v1
    v_and_b32 v44, 1, v44
    v_lshl_add_u32 v46, v50, 3, v44
    v_mul_u32_u24 v46, 3584, v46
    v_lshl_add_u32 v250, v45, 4, v46
    s_cmp_eq_u32 s3, 3
    s_cselect_b32 s63, 8, 16
    s_cselect_b32 s9, 32, 64
    v_cmp_gt_u32 vcc, s63, v45
    s_nop 1
    v_cndmask_b32 v250, v49, v250, vcc
    s_lshl_b32 s30, s4, 2
    s_add_u32 s30, s30, s5
    s_lshl_b32 s30, s30, 13
    s_add_u32 s30, s30, 589824
    s_lshl_b32 s27, s6, 8
    s_add_u32 s27, s27, s30
    s_add_u32 s28, s27, 0x4000
    s_lshl_b32 s63, s29, 14
    s_add_u32 s30, s30, s63
    s_lshl_b32 s63, s31, 11
    s_add_u32 s30, s30, s63
    v_lshlrev_b32 v46, 4, v48
    v_lshl_add_u32 v46, v44, 7, v46
    s_lshl_b32 s63, s3, 9
    v_lshl_add_u32 v44, v50, 8, s63
    v_add_u32 v245, v44, v46
    v_lshlrev_b32 v252, 2, v1
    v_bfe_u32 v44, v1, 3, 1
    v_lshl_add_u32 v44, v44, 1, v50
    s_cmp_eq_u32 s3, 3
    s_cselect_b32 s63, 8, 11
    v_lshl_add_u32 v62, v44, s63, v46
    v_lshrrev_b32 v44, 3, v1
    v_lshlrev_b32 v246, 5, v44
    v_bfe_u32 v44, v1, 1, 2
    v_cmp_eq_u32 vcc, 0, v44
    s_nop 1
    v_cndmask_b32 v240, 0, v47, vcc
    v_cmp_eq_u32 vcc, 1, v44
    s_nop 1
    v_cndmask_b32 v241, 0, v47, vcc
    v_cmp_eq_u32 vcc, 2, v44
    s_nop 1
    v_cndmask_b32 v242, 0, v47, vcc
    v_cmp_eq_u32 vcc, 3, v44
    s_nop 1
    v_cndmask_b32 v243, 0, v47, vcc
    s_lshl_b32 s63, s3, 10
    v_add_u32 v247, s63, v2
    s_lshl_b32 s8, s29, 1
    s_add_u32 s8, s8, s5
    s_lshl_b32 s60, s8, 2
    s_add_u32 s60, s60, s3
    s_mul_i32 s60, s60, 4096
    s_add_u32 s60, s60, 2752512
    s_add_u32 s18, s60, 2048
    v_lshrrev_b32 v44, 3, v1
    v_mul_u32_u24 v44, 256, v44
    v_lshl_add_u32 v248, v48, 3, v44
    v_lshl_add_u32 v253, v48, 1, v246
    v_cmp_gt_u32 vcc, s9, v1
    s_nop 1
    v_cndmask_b32 v248, v49, v248, vcc
    v_cndmask_b32 v253, v49, v253, vcc
    s_mul_i32 s9, s5, 1792
    s_mul_i32 s63, s29, 896
    s_add_u32 s9, s9, s63
    s_lshl_b32 s63, s3, 8
    s_add_u32 s9, s9, s63
    s_cmp_eq_u32 s3, 3
    s_cbranch_scc1 L_hret
    s_cmp_ge_u32 s37, s38
    s_cbranch_scc1 L_Vre
L_V:
    v_add_u32 v52, s92, v11
    ds_read_b128 v[18:21], v52 offset:2048
    ds_read_b128 v[22:25], v52 offset:2064
    s_waitcnt lgkmcnt(1)
    v_and_b32 v128, v18, v14
    v_and_b32 v129, v18, v15
    v_and_b32 v130, v18, v16
    v_and_b32 v131, v18, v17
    v_and_b32 v132, v19, v14
    v_and_b32 v133, v19, v15
    v_and_b32 v134, v19, v16
    v_and_b32 v135, v19, v17
    v_and_b32 v136, v20, v14
    v_and_b32 v137, v20, v15
    v_and_b32 v138, v20, v16
    v_and_b32 v139, v20, v17
    v_and_b32 v140, v21, v14
    v_and_b32 v141, v21, v15
    v_and_b32 v142, v21, v16
    v_and_b32 v143, v21, v17
    s_waitcnt lgkmcnt(0)
    v_and_b32 v144, v22, v14
    v_and_b32 v145, v22, v15
    v_and_b32 v146, v22, v16
    v_and_b32 v147, v22, v17
    v_and_b32 v148, v23, v14
    v_and_b32 v149, v23, v15
    v_and_b32 v150, v23, v16
    v_and_b32 v151, v23, v17
    v_and_b32 v152, v24, v14
    v_and_b32 v153, v24, v15
    v_and_b32 v154, v24, v16
    v_and_b32 v155, v24, v17
    v_and_b32 v156, v25, v14
    v_and_b32 v157, v25, v15
    v_and_b32 v158, v25, v16
    v_and_b32 v159, v25, v17
    s_waitcnt vmcnt(0)
    s_mov_b64 exec, 1
    ds_add_rtn_u32 v59, v56, v58
    s_mov_b64 exec, -1
    v_mfma_f32_16x16x32_bf16 v[28:31], v[64:67], v[128:131], v[28:31]
    v_mfma_f32_16x16x32_bf16 v[28:31], v[68:71], v[132:135], v[28:31]
    v_mfma_f32_16x16x32_bf16 v[28:31], v[72:75], v[136:139], v[28:31]
    v_mfma_f32_16x16x32_bf16 v[28:31], v[76:79], v[140:143], v[28:31]
    v_mfma_f32_16x16x32_bf16 v[28:31], v[80:83], v[144:147], v[28:31]
    v_mfma_f32_16x16x32_bf16 v[28:31], v[84:87], v[148:151], v[28:31]
    v_mfma_f32_16x16x32_bf16 v[28:31], v[88:91], v[152:155], v[28:31]
    v_mfma_f32_16x16x32_bf16 v[28:31], v[92:95], v[156:159], v[28:31]
    s_waitcnt lgkmcnt(0)
    v_readfirstlane_b32 s36, v59
    s_nop 0
    s_and_b32 s37, s36, 0xff
L_Vre:
    s_cmp_ge_u32 s37, s38
    s_cselect_b64 s[64:65], s[96:97], s[64:65]
    s_cmov_b64 s[34:35], s[74:75]
    s_cmov_b64 s[68:69], s[100:101]
    s_cmov_b64 s[70:71], s[24:25]
    s_cselect_b64 vcc, -1, 0
    v_cndmask_b32 v3, v3, v4, vcc
    s_add_u32 s90, s36, s35
    s_lshl_b32 s90, s90, s70
    s_and_b32 s92, s90, s71
    s_and_b32 s7, s90, s68
    s_lshl_b32 s7, s7, 10
    s_and_b32 s90, s90, s69
    s_lshl_b32 s90, s90, 7
    s_add_u32 s90, s90, s34
    s_add_u32 s90, s90, s7
    s_add_u32 s91, s90, 4096
    s_bitcmp1_b32 s37, 7
    s_cbranch_scc1 L_x0
    buffer_load_dwordx4 v[64:67], v3, s[64:67], s90 offen offset:0 nt
    buffer_load_dwordx4 v[68:71], v3, s[64:67], s90 offen offset:1024 nt
    buffer_load_dwordx4 v[72:75], v3, s[64:67], s90 offen offset:2048 nt
    buffer_load_dwordx4 v[76:79], v3, s[64:67], s90 offen offset:3072 nt
    buffer_load_dwordx4 v[80:83], v3, s[64:67], s91 offen offset:0 nt
    buffer_load_dwordx4 v[84:87], v3, s[64:67], s91 offen offset:1024 nt
    buffer_load_dwordx4 v[88:91], v3, s[64:67], s91 offen offset:2048 nt
    buffer_load_dwordx4 v[92:95], v3, s[64:67], s91 offen offset:3072 nt
    s_cmp_ge_u32 s37, s38
    s_cbranch_scc1 L_bnd
L_Vc:
    s_cmp_ge_u32 s37, s73
    s_cbranch_scc1 L_l1
    s_lshr_b32 s63, s36, 24
    s_sub_i32 s63, s63, s89
    s_cmp_ge_i32 s37, s63
    s_cbranch_scc1 L_V
    s_mov_b64 exec, 1
    ds_add_rtn_u32 v59, v56, v58
    s_mov_b64 exec, -1
    s_waitcnt lgkmcnt(0)
    v_readfirstlane_b32 s36, v59
    s_nop 0
    s_and_b32 s37, s36, 0xff
    s_add_u32 s90, s36, s35
    s_lshl_b32 s90, s90, s70
    s_and_b32 s93, s90, s71
    s_and_b32 s7, s90, s68
    s_lshl_b32 s7, s7, 10
    s_and_b32 s90, s90, s69
    s_lshl_b32 s90, s90, 7
    s_add_u32 s90, s90, s34
    s_add_u32 s90, s90, s7
    s_add_u32 s91, s90, 4096
    s_cmp_ge_u32 s37, s38
    s_cbranch_scc1 L_xX
    buffer_load_dwordx4 v[96:99], v3, s[64:67], s90 offen offset:0 nt
    buffer_load_dwordx4 v[100:103], v3, s[64:67], s90 offen offset:1024 nt
    buffer_load_dwordx4 v[104:107], v3, s[64:67], s90 offen offset:2048 nt
    buffer_load_dwordx4 v[108:111], v3, s[64:67], s90 offen offset:3072 nt
    buffer_load_dwordx4 v[112:115], v3, s[64:67], s91 offen offset:0 nt
    buffer_load_dwordx4 v[116:119], v3, s[64:67], s91 offen offset:1024 nt
    buffer_load_dwordx4 v[120:123], v3, s[64:67], s91 offen offset:2048 nt
    buffer_load_dwordx4 v[124:127], v3, s[64:67], s91 offen offset:3072 nt
L_loop2:
    v_add_u32 v52, s92, v11
    ds_read_b128 v[18:21], v52 offset:2048
    ds_read_b128 v[22:25], v52 offset:2064
    s_waitcnt lgkmcnt(1)
    v_and_b32 v128, v18, v14
    v_and_b32 v129, v18, v15
    v_and_b32 v130, v18, v16
    v_and_b32 v131, v18, v17
    v_and_b32 v132, v19, v14
    v_and_b32 v133, v19, v15
    v_and_b32 v134, v19, v16
    v_and_b32 v135, v19, v17
    v_and_b32 v136, v20, v14
    v_and_b32 v137, v20, v15
    v_and_b32 v138, v20, v16
    v_and_b32 v139, v20, v17
    v_and_b32 v140, v21, v14
    v_and_b32 v141, v21, v15
    v_and_b32 v142, v21, v16
    v_and_b32 v143, v21, v17
    s_waitcnt lgkmcnt(0)
    v_and_b32 v144, v22, v14
    v_and_b32 v145, v22, v15
    v_and_b32 v146, v22, v16
    v_and_b32 v147, v22, v17
    v_and_b32 v148, v23, v14
    v_and_b32 v149, v23, v15
    v_and_b32 v150, v23, v16
    v_and_b32 v151, v23, v17
    v_and_b32 v152, v24, v14
    v_and_b32 v153, v24, v15
    v_and_b32 v154, v24, v16
    v_and_b32 v155, v24, v17
    v_and_b32 v156, v25, v14
    v_and_b32 v157, v25, v15
    v_and_b32 v158, v25, v16
    v_and_b32 v159, v25, v17
    s_waitcnt vmcnt(12)
    s_mov_b64 exec, 1
    ds_add_rtn_u32 v59, v56, v58
    s_mov_b64 exec, -1
    v_mfma_f32_16x16x32_bf16 v[28:31], v[64:67], v[128:131], v[28:31]
    v_mfma_f32_16x16x32_bf16 v[28:31], v[68:71], v[132:135], v[28:31]
    v_mfma_f32_16x16x32_bf16 v[28:31], v[72:75], v[136:139], v[28:31]
    v_mfma_f32_16x16x32_bf16 v[28:31], v[76:79], v[140:143], v[28:31]
    s_waitcnt lgkmcnt(0)
    v_readfirstlane_b32 s36, v59
    s_nop 0
    s_and_b32 s37, s36, 0xff
    s_cmp_ge_u32 s37, s38
    s_cselect_b64 s[64:65], s[96:97], s[64:65]
    s_cmov_b64 s[34:35], s[74:75]
    s_cmov_b64 s[68:69], s[100:101]
    s_cmov_b64 s[70:71], s[24:25]
    s_cselect_b64 vcc, -1, 0
    v_cndmask_b32 v3, v3, v4, vcc
    s_add_u32 s90, s36, s35
    s_lshl_b32 s90, s90, s70
    s_and_b32 s92, s90, s71
    s_and_b32 s7, s90, s68
    s_lshl_b32 s7, s7, 10
    s_and_b32 s90, s90, s69
    s_lshl_b32 s90, s90, 7
    s_add_u32 s90, s90, s34
    s_add_u32 s90, s90, s7
    s_add_u32 s91, s90, 4096
    s_waitcnt vmcnt(8)
    v_mfma_f32_16x16x32_bf16 v[28:31], v[80:83], v[144:147], v[28:31]
    v_mfma_f32_16x16x32_bf16 v[28:31], v[84:87], v[148:151], v[28:31]
    v_mfma_f32_16x16x32_bf16 v[28:31], v[88:91], v[152:155], v[28:31]
    v_mfma_f32_16x16x32_bf16 v[28:31], v[92:95], v[156:159], v[28:31]
    s_bitcmp1_b32 s37, 7
    s_cbranch_scc1 L_xY
    buffer_load_dwordx4 v[64:67], v3, s[64:67], s90 offen offset:0 nt
    buffer_load_dwordx4 v[68:71], v3, s[64:67], s90 offen offset:1024 nt
    buffer_load_dwordx4 v[72:75], v3, s[64:67], s90 offen offset:2048 nt
    buffer_load_dwordx4 v[76:79], v3, s[64:67], s90 offen offset:3072 nt
    buffer_load_dwordx4 v[80:83], v3, s[64:67], s91 offen offset:0 nt
    buffer_load_dwordx4 v[84:87], v3, s[64:67], s91 offen offset:1024 nt
    buffer_load_dwordx4 v[88:91], v3, s[64:67], s91 offen offset:2048 nt
    buffer_load_dwordx4 v[92:95], v3, s[64:67], s91 offen offset:3072 nt
    s_lshr_b32 s63, s36, 24
    s_sub_i32 s63, s63, s89
    s_min_i32 s63, s63, s38
    s_cmp_ge_i32 s37, s63
    s_cbranch_scc1 L_VY
    v_add_u32 v52, s93, v11
    ds_read_b128 v[18:21], v52 offset:2048
    ds_read_b128 v[22:25], v52 offset:2064
    s_waitcnt lgkmcnt(1)
    v_and_b32 v128, v18, v14
    v_and_b32 v129, v18, v15
    v_and_b32 v130, v18, v16
    v_and_b32 v131, v18, v17
    v_and_b32 v132, v19, v14
    v_and_b32 v133, v19, v15
    v_and_b32 v134, v19, v16
    v_and_b32 v135, v19, v17
    v_and_b32 v136, v20, v14
    v_and_b32 v137, v20, v15
    v_and_b32 v138, v20, v16
    v_and_b32 v139, v20, v17
    v_and_b32 v140, v21, v14
    v_and_b32 v141, v21, v15
    v_and_b32 v142, v21, v16
    v_and_b32 v143, v21, v17
    s_waitcnt lgkmcnt(0)
    v_and_b32 v144, v22, v14
    v_and_b32 v145, v22, v15
    v_and_b32 v146, v22, v16
    v_and_b32 v147, v22, v17
    v_and_b32 v148, v23, v14
    v_and_b32 v149, v23, v15
    v_and_b32 v150, v23, v16
    v_and_b32 v151, v23, v17
    v_and_b32 v152, v24, v14
    v_and_b32 v153, v24, v15
    v_and_b32 v154, v24, v16
    v_and_b32 v155, v24, v17
    v_and_b32 v156, v25, v14
    v_and_b32 v157, v25, v15
    v_and_b32 v158, v25, v16
    v_and_b32 v159, v25, v17
    s_waitcnt vmcnt(12)
    s_mov_b64 exec, 1
    ds_add_rtn_u32 v59, v56, v58
    s_mov_b64 exec, -1
    v_mfma_f32_16x16x32_bf16 v[28:31], v[96:99], v[128:131], v[28:31]
    v_mfma_f32_16x16x32_bf16 v[28:31], v[100:103], v[132:135], v[28:31]
    v_mfma_f32_16x16x32_bf16 v[28:31], v[104:107], v[136:139], v[28:31]
    v_mfma_f32_16x16x32_bf16 v[28:31], v[108:111], v[140:143], v[28:31]
    s_waitcnt lgkmcnt(0)
    v_readfirstlane_b32 s36, v59
    s_nop 0
    s_and_b32 s37, s36, 0xff
    s_add_u32 s90, s36, s35
    s_lshl_b32 s90, s90, s70
    s_and_b32 s93, s90, s71
    s_and_b32 s7, s90, s68
    s_lshl_b32 s7, s7, 10
    s_and_b32 s90, s90, s69
    s_lshl_b32 s90, s90, 7
    s_add_u32 s90, s90, s34
    s_add_u32 s90, s90, s7
    s_add_u32 s91, s90, 4096
    s_waitcnt vmcnt(8)
    v_mfma_f32_16x16x32_bf16 v[28:31], v[112:115], v[144:147], v[28:31]
    v_mfma_f32_16x16x32_bf16 v[28:31], v[116:119], v[148:151], v[28:31]
    v_mfma_f32_16x16x32_bf16 v[28:31], v[120:123], v[152:155], v[28:31]
    v_mfma_f32_16x16x32_bf16 v[28:31], v[124:127], v[156:159], v[28:31]
    s_cmp_ge_u32 s37, s38
    s_cbranch_scc1 L_xX
    buffer_load_dwordx4 v[96:99], v3, s[64:67], s90 offen offset:0 nt
    buffer_load_dwordx4 v[100:103], v3, s[64:67], s90 offen offset:1024 nt
    buffer_load_dwordx4 v[104:107], v3, s[64:67], s90 offen offset:2048 nt
    buffer_load_dwordx4 v[108:111], v3, s[64:67], s90 offen offset:3072 nt
    buffer_load_dwordx4 v[112:115], v3, s[64:67], s91 offen offset:0 nt
    buffer_load_dwordx4 v[116:119], v3, s[64:67], s91 offen offset:1024 nt
    buffer_load_dwordx4 v[120:123], v3, s[64:67], s91 offen offset:2048 nt
    buffer_load_dwordx4 v[124:127], v3, s[64:67], s91 offen offset:3072 nt
    s_branch L_loop2
L_VY:
    v_add_u32 v52, s93, v11
    ds_read_b128 v[18:21], v52 offset:2048
    ds_read_b128 v[22:25], v52 offset:2064
    s_waitcnt lgkmcnt(1)
    v_and_b32 v128, v18, v14
    v_and_b32 v129, v18, v15
    v_and_b32 v130, v18, v16
    v_and_b32 v131, v18, v17
    v_and_b32 v132, v19, v14
    v_and_b32 v133, v19, v15
    v_and_b32 v134, v19, v16
    v_and_b32 v135, v19, v17
    v_and_b32 v136, v20, v14
    v_and_b32 v137, v20, v15
    v_and_b32 v138, v20, v16
    v_and_b32 v139, v20, v17
    v_and_b32 v140, v21, v14
    v_and_b32 v141, v21, v15
    v_and_b32 v142, v21, v16
    v_and_b32 v143, v21, v17
    s_waitcnt lgkmcnt(0)
    v_and_b32 v144, v22, v14
    v_and_b32 v145, v22, v15
    v_and_b32 v146, v22, v16
    v_and_b32 v147, v22, v17
    v_and_b32 v148, v23, v14
    v_and_b32 v149, v23, v15
    v_and_b32 v150, v23, v16
    v_and_b32 v151, v23, v17
    v_and_b32 v152, v24, v14
    v_and_b32 v153, v24, v15
    v_and_b32 v154, v24, v16
    v_and_b32 v155, v24, v17
    v_and_b32 v156, v25, v14
    v_and_b32 v157, v25, v15
    v_and_b32 v158, v25, v16
    v_and_b32 v159, v25, v17
    s_waitcnt vmcnt(12)
    v_mfma_f32_16x16x32_bf16 v[28:31], v[96:99], v[128:131], v[28:31]
    v_mfma_f32_16x16x32_bf16 v[28:31], v[100:103], v[132:135], v[28:31]
    v_mfma_f32_16x16x32_bf16 v[28:31], v[104:107], v[136:139], v[28:31]
    v_mfma_f32_16x16x32_bf16 v[28:31], v[108:111], v[140:143], v[28:31]
    s_waitcnt vmcnt(8)
    v_mfma_f32_16x16x32_bf16 v[28:31], v[112:115], v[144:147], v[28:31]
    v_mfma_f32_16x16x32_bf16 v[28:31], v[116:119], v[148:151], v[28:31]
    v_mfma_f32_16x16x32_bf16 v[28:31], v[120:123], v[152:155], v[28:31]
    v_mfma_f32_16x16x32_bf16 v[28:31], v[124:127], v[156:159], v[28:31]
    s_cmp_lt_u32 s37, s38
    s_cbranch_scc1 L_V
L_bnd:
    s_cmp_eq_u32 s38, 120
    s_cbranch_scc1 L_bB
    s_mov_b32 s63, s36
L_ww0:
    s_bitcmp1_b32 s63, 21
    s_cbranch_scc1 L_ww0x
    ds_read_b32 v59, v56
    s_sub_u32 s39, s39, 1
    s_waitcnt lgkmcnt(0)
    v_readfirstlane_b32 s63, v59
    s_cmp_gt_i32 s39, 0
    s_cbranch_scc1 L_ww0
L_ww0x:
    ds_read_b32 v26, v56 offset:16
    s_add_u32 s62, s27, 1376256
    s_waitcnt lgkmcnt(0)
    v_mul_f32 v44, v26, v28
    v_mul_f32 v45, v26, v29
    v_mul_f32 v46, v26, v30
    v_mul_f32 v47, v26, v31
    ds_write_b128 v247, v[44:47] offset:8192
    s_mov_b64 exec, 1
    ds_add_rtn_u32 v59, v56, v58 offset:4
    s_mov_b64 exec, -1
    ds_read_b128 v[96:99], v2 offset:8192
    ds_read_b128 v[100:103], v2 offset:9216
    ds_read_b128 v[104:107], v2 offset:10240
    v_mov_b32 v28, 0
    v_mov_b32 v29, 0
    v_mov_b32 v30, 0
    v_mov_b32 v31, 0
    s_waitcnt lgkmcnt(1)
    v_readfirstlane_b32 s63, v59
    v_add_f32 v44, v96, v100
    v_add_f32 v45, v97, v101
    v_add_f32 v46, v98, v102
    v_add_f32 v47, v99, v103
    s_cmp_lg_u32 s63, 2
    s_waitcnt lgkmcnt(0)
    s_cbranch_scc1 L_dx0
    v_add_f32 v44, v44, v104
    v_add_f32 v45, v45, v105
    v_add_f32 v46, v46, v106
    v_add_f32 v47, v47, v107
    v_bfi_b32 v44, v251, s56, v44
    v_bfi_b32 v45, v251, s57, v45
    v_bfi_b32 v46, v251, s58, v46
    v_bfi_b32 v47, v251, s88, v47
    buffer_store_dwordx4 v[44:47], v62, s[80:83], s27 offen
    s_cmp_eq_u32 s99, 0
    s_cbranch_scc1 L_dx0
    v_bfi_b32 v44, v251, s56, v44
    v_bfi_b32 v45, v251, s57, v45
    v_bfi_b32 v46, v251, s58, v46
    v_bfi_b32 v47, v251, s59, v47
    buffer_store_dwordx4 v[44:47], v62, s[80:83], s62 offen sc1
L_dx0:
    s_mov_b32 s38, 120
    s_lshl_b32 s75, s35, 1
    s_sub_u32 s75, s75, 8
    s_andn2_b32 s74, s34, 0x1fffff
    s_lshl_b32 s7, s31, 7
    s_add_u32 s74, s74, s7
    s_bitcmp1_b32 s6, 2
    s_cselect_b64 s[96:97], s[22:23], s[12:13]
    s_mov_b32 s100, 0
    s_movk_i32 s101, 0x3f00
    s_mov_b32 s24, 8
    s_movk_i32 s25, 0xf00
    v_lshrrev_b32 v44, 4, v1
    v_lshlrev_b32 v44, 13, v44
    v_bfe_u32 v45, v1, 3, 1
    v_lshl_add_u32 v44, v45, 9, v44
    v_and_b32 v45, 7, v1
    v_lshl_add_u32 v4, v45, 4, v44
    v_add_u32 v11, 2048, v11
    s_mov_b32 s63, s36
L_wpb:
    s_bitcmp1_b32 s63, 22
    s_cbranch_scc1 L_wpbx
    ds_read_b32 v59, v56
    s_sub_u32 s39, s39, 1
    s_waitcnt lgkmcnt(0)
    v_readfirstlane_b32 s63, v59
    s_cmp_gt_i32 s39, 0
    s_cbranch_scc1 L_wpb
L_wpbx:
    s_cmp_lt_u32 s37, s38
    s_cbranch_scc1 L_Vc
    s_branch L_Vre
L_bB:
    s_mov_b32 s63, s36
L_ww1:
    s_bitcmp1_b32 s63, 23
    s_cbranch_scc1 L_ww1x
    ds_read_b32 v59, v56
    s_sub_u32 s39, s39, 1
    s_waitcnt lgkmcnt(0)
    v_readfirstlane_b32 s63, v59
    s_cmp_gt_i32 s39, 0
    s_cbranch_scc1 L_ww1
L_ww1x:
    ds_read_b32 v26, v56 offset:20
    s_add_u32 s62, s28, 1376256
    s_waitcnt lgkmcnt(0)
    v_mul_f32 v44, v26, v28
    v_mul_f32 v45, v26, v29
    v_mul_f32 v46, v26, v30
    v_mul_f32 v47, v26, v31
    ds_write_b128 v247, v[44:47] offset:11264
    s_mov_b64 exec, 1
    ds_add_rtn_u32 v59, v56, v58 offset:8
    s_mov_b64 exec, -1
    ds_read_b128 v[96:99], v2 offset:11264
    ds_read_b128 v[100:103], v2 offset:12288
    ds_read_b128 v[104:107], v2 offset:13312
    v_mov_b32 v28, 0
    v_mov_b32 v29, 0
    v_mov_b32 v30, 0
    v_mov_b32 v31, 0
    s_waitcnt lgkmcnt(1)
    v_readfirstlane_b32 s63, v59
    v_add_f32 v44, v96, v100
    v_add_f32 v45, v97, v101
    v_add_f32 v46, v98, v102
    v_add_f32 v47, v99, v103
    s_cmp_lg_u32 s63, 2
    s_waitcnt lgkmcnt(0)
    s_cbranch_scc1 L_dx1
    v_add_f32 v44, v44, v104
    v_add_f32 v45, v45, v105
    v_add_f32 v46, v46, v106
    v_add_f32 v47, v47, v107
    v_bfi_b32 v44, v251, s56, v44
    v_bfi_b32 v45, v251, s57, v45
    v_bfi_b32 v46, v251, s58, v46
    v_bfi_b32 v47, v251, s88, v47
    buffer_store_dwordx4 v[44:47], v62, s[80:83], s28 offen
    s_cmp_eq_u32 s99, 0
    s_cbranch_scc1 L_dx1
    v_bfi_b32 v44, v251, s56, v44
    v_bfi_b32 v45, v251, s57, v45
    v_bfi_b32 v46, v251, s58, v46
    v_bfi_b32 v47, v251, s59, v47
    buffer_store_dwordx4 v[44:47], v62, s[80:83], s62 offen sc1
L_dx1:
    s_movk_i32 s38, 128
    s_movk_i32 s73, 126
    v_add_u32 v11, 12288, v246
    v_mov_b32 v14, v240
    v_mov_b32 v15, v241
    v_mov_b32 v16, v242
    v_mov_b32 v17, v243
    s_mov_b32 s63, s36
L_wlp:
    s_bitcmp1_b32 s63, 16
    s_cbranch_scc1 L_wlpx
    ds_read_b32 v59, v56
    s_sub_u32 s39, s39, 1
    s_waitcnt lgkmcnt(0)
    v_readfirstlane_b32 s63, v59
    s_cmp_gt_i32 s39, 0
    s_cbranch_scc1 L_wlp
L_wlpx:
    s_cmp_lt_u32 s37, s38
    s_cbranch_scc1 L_Vc
L_x0:
    s_bitcmp0_b32 s38, 7
    s_cbranch_scc1 L_bnd
    s_bitcmp1_b32 s73, 8
    s_cbranch_scc1 L_done
    buffer_load_dwordx4 v[160:163], v250, s[76:79], s14 offen offset:0
    buffer_load_dwordx4 v[164:167], v250, s[76:79], s14 offen offset:1792
    buffer_load_dwordx4 v[168:171], v250, s[76:79], s15 offen offset:0
    buffer_load_dwordx4 v[172:175], v250, s[76:79], s15 offen offset:1792
    buffer_load_dwordx4 v[176:179], v250, s[76:79], s16 offen offset:0
    buffer_load_dwordx4 v[180:183], v250, s[76:79], s16 offen offset:1792
    buffer_load_dwordx4 v[184:187], v250, s[76:79], s17 offen offset:0
    buffer_load_dwordx4 v[188:191], v250, s[76:79], s17 offen offset:1792
    buffer_load_dwordx4 v[192:195], v250, s[76:79], s14 offen offset:896
    buffer_load_dwordx4 v[196:199], v250, s[76:79], s14 offen offset:2688
    buffer_load_dwordx4 v[200:203], v250, s[76:79], s15 offen offset:896
    buffer_load_dwordx4 v[204:207], v250, s[76:79], s15 offen offset:2688
    buffer_load_dwordx4 v[208:211], v250, s[76:79], s16 offen offset:896
    buffer_load_dwordx4 v[212:215], v250, s[76:79], s16 offen offset:2688
    buffer_load_dwordx4 v[216:219], v250, s[76:79], s17 offen offset:896
    buffer_load_dwordx4 v[220:223], v250, s[76:79], s17 offen offset:2688
    s_branch L_done
L_xY:
    v_add_u32 v52, s93, v11
    ds_read_b128 v[18:21], v52 offset:2048
    ds_read_b128 v[22:25], v52 offset:2064
    s_waitcnt lgkmcnt(1)
    v_and_b32 v128, v18, v14
    v_and_b32 v129, v18, v15
    v_and_b32 v130, v18, v16
    v_and_b32 v131, v18, v17
    v_and_b32 v132, v19, v14
    v_and_b32 v133, v19, v15
    v_and_b32 v134, v19, v16
    v_and_b32 v135, v19, v17
    v_and_b32 v136, v20, v14
    v_and_b32 v137, v20, v15
    v_and_b32 v138, v20, v16
    v_and_b32 v139, v20, v17
    v_and_b32 v140, v21, v14
    v_and_b32 v141, v21, v15
    v_and_b32 v142, v21, v16
    v_and_b32 v143, v21, v17
    s_waitcnt lgkmcnt(0)
    v_and_b32 v144, v22, v14
    v_and_b32 v145, v22, v15
    v_and_b32 v146, v22, v16
    v_and_b32 v147, v22, v17
    v_and_b32 v148, v23, v14
    v_and_b32 v149, v23, v15
    v_and_b32 v150, v23, v16
    v_and_b32 v151, v23, v17
    v_and_b32 v152, v24, v14
    v_and_b32 v153, v24, v15
    v_and_b32 v154, v24, v16
    v_and_b32 v155, v24, v17
    v_and_b32 v156, v25, v14
    v_and_b32 v157, v25, v15
    v_and_b32 v158, v25, v16
    v_and_b32 v159, v25, v17
    s_bitcmp1_b32 s73, 8
    s_cbranch_scc1 L_tY
    buffer_load_dwordx4 v[160:163], v250, s[76:79], s14 offen offset:0
    buffer_load_dwordx4 v[164:167], v250, s[76:79], s14 offen offset:1792
    buffer_load_dwordx4 v[168:171], v250, s[76:79], s15 offen offset:0
    buffer_load_dwordx4 v[172:175], v250, s[76:79], s15 offen offset:1792
    buffer_load_dwordx4 v[176:179], v250, s[76:79], s16 offen offset:0
    buffer_load_dwordx4 v[180:183], v250, s[76:79], s16 offen offset:1792
    buffer_load_dwordx4 v[184:187], v250, s[76:79], s17 offen offset:0
    buffer_load_dwordx4 v[188:191], v250, s[76:79], s17 offen offset:1792
    buffer_load_dwordx4 v[192:195], v250, s[76:79], s14 offen offset:896
    buffer_load_dwordx4 v[196:199], v250, s[76:79], s14 offen offset:2688
    buffer_load_dwordx4 v[200:203], v250, s[76:79], s15 offen offset:896
    buffer_load_dwordx4 v[204:207], v250, s[76:79], s15 offen offset:2688
    buffer_load_dwordx4 v[208:211], v250, s[76:79], s16 offen offset:896
    buffer_load_dwordx4 v[212:215], v250, s[76:79], s16 offen offset:2688
    buffer_load_dwordx4 v[216:219], v250, s[76:79], s17 offen offset:896
    buffer_load_dwordx4 v[220:223], v250, s[76:79], s17 offen offset:2688
    s_waitcnt vmcnt(20)
    v_mfma_f32_16x16x32_bf16 v[28:31], v[96:99], v[128:131], v[28:31]
    v_mfma_f32_16x16x32_bf16 v[28:31], v[100:103], v[132:135], v[28:31]
    v_mfma_f32_16x16x32_bf16 v[28:31], v[104:107], v[136:139], v[28:31]
    v_mfma_f32_16x16x32_bf16 v[28:31], v[108:111], v[140:143], v[28:31]
    s_waitcnt vmcnt(19)
    v_mfma_f32_16x16x32_bf16 v[28:31], v[112:115], v[144:147], v[28:31]
    s_waitcnt vmcnt(18)
    v_mfma_f32_16x16x32_bf16 v[28:31], v[116:119], v[148:151], v[28:31]
    s_waitcnt vmcnt(17)
    v_mfma_f32_16x16x32_bf16 v[28:31], v[120:123], v[152:155], v[28:31]
    s_waitcnt vmcnt(16)
    v_mfma_f32_16x16x32_bf16 v[28:31], v[124:127], v[156:159], v[28:31]
    s_nop 4
    s_branch L_done
L_tY:
    s_waitcnt vmcnt(4)
    v_mfma_f32_16x16x32_bf16 v[28:31], v[96:99], v[128:131], v[28:31]
    v_mfma_f32_16x16x32_bf16 v[28:31], v[100:103], v[132:135], v[28:31]
    v_mfma_f32_16x16x32_bf16 v[28:31], v[104:107], v[136:139], v[28:31]
    v_mfma_f32_16x16x32_bf16 v[28:31], v[108:111], v[140:143], v[28:31]
    s_waitcnt vmcnt(3)
    v_mfma_f32_16x16x32_bf16 v[28:31], v[112:115], v[144:147], v[28:31]
    s_waitcnt vmcnt(2)
    v_mfma_f32_16x16x32_bf16 v[28:31], v[116:119], v[148:151], v[28:31]
    s_waitcnt vmcnt(1)
    v_mfma_f32_16x16x32_bf16 v[28:31], v[120:123], v[152:155], v[28:31]
    s_waitcnt vmcnt(0)
    v_mfma_f32_16x16x32_bf16 v[28:31], v[124:127], v[156:159], v[28:31]
    s_branch L_x1
L_tX:
    s_waitcnt vmcnt(4)
    v_mfma_f32_16x16x32_bf16 v[28:31], v[64:67], v[128:131], v[28:31]
    v_mfma_f32_16x16x32_bf16 v[28:31], v[68:71], v[132:135], v[28:31]
    v_mfma_f32_16x16x32_bf16 v[28:31], v[72:75], v[136:139], v[28:31]
    v_mfma_f32_16x16x32_bf16 v[28:31], v[76:79], v[140:143], v[28:31]
    s_waitcnt vmcnt(3)
    v_mfma_f32_16x16x32_bf16 v[28:31], v[80:83], v[144:147], v[28:31]
    s_waitcnt vmcnt(2)
    v_mfma_f32_16x16x32_bf16 v[28:31], v[84:87], v[148:151], v[28:31]
    s_waitcnt vmcnt(1)
    v_mfma_f32_16x16x32_bf16 v[28:31], v[88:91], v[152:155], v[28:31]
    s_waitcnt vmcnt(0)
    v_mfma_f32_16x16x32_bf16 v[28:31], v[92:95], v[156:159], v[28:31]
L_x1:
    s_bitcmp0_b32 s38, 7
    s_cbranch_scc1 L_Vre
    s_nop 2
    s_branch L_done
L_l1:
    s_add_u32 s63, s37, 1
L_wsp:
    s_cmp_ge_u32 s63, 128
    s_cbranch_scc1 L_xX
    ds_read_b32 v59, v56
    s_sub_u32 s39, s39, 1
    s_waitcnt lgkmcnt(0)
    v_readfirstlane_b32 s63, v59
    s_nop 0
    s_and_b32 s63, s63, 0xff
    s_cmp_gt_i32 s39, 0
    s_cbranch_scc1 L_wsp
L_xX:
    v_add_u32 v52, s92, v11
    ds_read_b128 v[18:21], v52 offset:2048
    ds_read_b128 v[22:25], v52 offset:2064
    s_waitcnt lgkmcnt(1)
    v_and_b32 v128, v18, v14
    v_and_b32 v129, v18, v15
    v_and_b32 v130, v18, v16
    v_and_b32 v131, v18, v17
    v_and_b32 v132, v19, v14
    v_and_b32 v133, v19, v15
    v_and_b32 v134, v19, v16
    v_and_b32 v135, v19, v17
    v_and_b32 v136, v20, v14
    v_and_b32 v137, v20, v15
    v_and_b32 v138, v20, v16
    v_and_b32 v139, v20, v17
    v_and_b32 v140, v21, v14
    v_and_b32 v141, v21, v15
    v_and_b32 v142, v21, v16
    v_and_b32 v143, v21, v17
    s_waitcnt lgkmcnt(0)
    v_and_b32 v144, v22, v14
    v_and_b32 v145, v22, v15
    v_and_b32 v146, v22, v16
    v_and_b32 v147, v22, v17
    v_and_b32 v148, v23, v14
    v_and_b32 v149, v23, v15
    v_and_b32 v150, v23, v16
    v_and_b32 v151, v23, v17
    v_and_b32 v152, v24, v14
    v_and_b32 v153, v24, v15
    v_and_b32 v154, v24, v16
    v_and_b32 v155, v24, v17
    v_and_b32 v156, v25, v14
    v_and_b32 v157, v25, v15
    v_and_b32 v158, v25, v16
    v_and_b32 v159, v25, v17
    s_bitcmp1_b32 s73, 8
    s_cbranch_scc1 L_tX
L_fX:
    buffer_load_dwordx4 v[160:163], v250, s[76:79], s14 offen offset:0
    buffer_load_dwordx4 v[164:167], v250, s[76:79], s14 offen offset:1792
    buffer_load_dwordx4 v[168:171], v250, s[76:79], s15 offen offset:0
    buffer_load_dwordx4 v[172:175], v250, s[76:79], s15 offen offset:1792
    buffer_load_dwordx4 v[176:179], v250, s[76:79], s16 offen offset:0
    buffer_load_dwordx4 v[180:183], v250, s[76:79], s16 offen offset:1792
    buffer_load_dwordx4 v[184:187], v250, s[76:79], s17 offen offset:0
    buffer_load_dwordx4 v[188:191], v250, s[76:79], s17 offen offset:1792
    buffer_load_dwordx4 v[192:195], v250, s[76:79], s14 offen offset:896
    buffer_load_dwordx4 v[196:199], v250, s[76:79], s14 offen offset:2688
    buffer_load_dwordx4 v[200:203], v250, s[76:79], s15 offen offset:896
    buffer_load_dwordx4 v[204:207], v250, s[76:79], s15 offen offset:2688
    buffer_load_dwordx4 v[208:211], v250, s[76:79], s16 offen offset:896
    buffer_load_dwordx4 v[212:215], v250, s[76:79], s16 offen offset:2688
    buffer_load_dwordx4 v[216:219], v250, s[76:79], s17 offen offset:896
    buffer_load_dwordx4 v[220:223], v250, s[76:79], s17 offen offset:2688
    s_movk_i32 s73, 256
    s_waitcnt vmcnt(20)
    v_mfma_f32_16x16x32_bf16 v[28:31], v[64:67], v[128:131], v[28:31]
    v_mfma_f32_16x16x32_bf16 v[28:31], v[68:71], v[132:135], v[28:31]
    v_mfma_f32_16x16x32_bf16 v[28:31], v[72:75], v[136:139], v[28:31]
    v_mfma_f32_16x16x32_bf16 v[28:31], v[76:79], v[140:143], v[28:31]
    s_waitcnt vmcnt(19)
    v_mfma_f32_16x16x32_bf16 v[28:31], v[80:83], v[144:147], v[28:31]
    s_waitcnt vmcnt(18)
    v_mfma_f32_16x16x32_bf16 v[28:31], v[84:87], v[148:151], v[28:31]
    s_waitcnt vmcnt(17)
    v_mfma_f32_16x16x32_bf16 v[28:31], v[88:91], v[152:155], v[28:31]
    s_waitcnt vmcnt(16)
    v_mfma_f32_16x16x32_bf16 v[28:31], v[92:95], v[156:159], v[28:31]
L_done:
L_sum:
    s_mov_b32 exec_lo, 0x00ff00ff
    s_mov_b32 exec_hi, 0xff00ff00
    s_nop 5
    ds_write_b128 v245, v[28:31] offset:18432
    s_mov_b64 exec, -1
    s_waitcnt lgkmcnt(0)
    s_barrier
    ds_read2st64_b32 v[18:19], v252 offset0:72 offset1:73
    ds_read2st64_b32 v[20:21], v252 offset0:74 offset1:75
    ds_read2st64_b32 v[22:23], v252 offset0:76 offset1:77
    ds_read2st64_b32 v[24:25], v252 offset0:78 offset1:79
    s_waitcnt lgkmcnt(3)
    v_add_f32 v18, v18, v19
    s_waitcnt lgkmcnt(2)
    v_add_f32 v20, v20, v21
    v_add_f32 v18, v18, v20
    s_waitcnt lgkmcnt(1)
    v_add_f32 v22, v22, v23
    s_waitcnt lgkmcnt(0)
    v_add_f32 v24, v24, v25
    v_add_f32 v22, v22, v24
    v_add_f32 v18, v18, v22
    v_cvt_pk_bf16_f32 v44, v18, v18
    ds_write_b32 v252, v44 offset:20480
    ds_read_b128 v[18:21], v246 offset:20480
    ds_read_b128 v[22:25], v246 offset:20496
    s_waitcnt lgkmcnt(1)
    v_and_b32 v128, v18, v240
    v_and_b32 v129, v18, v241
    v_and_b32 v130, v18, v242
    v_and_b32 v131, v18, v243
    s_waitcnt vmcnt(14)
    v_and_b32 v132, v19, v240
    v_and_b32 v133, v19, v241
    v_mfma_f32_16x16x32_bf16 v[28:31], v[160:163], v[128:131], 0
    v_and_b32 v134, v19, v242
    v_and_b32 v135, v19, v243
    v_mfma_f32_16x16x32_bf16 v[32:35], v[164:167], v[128:131], 0
    s_waitcnt vmcnt(12)
    v_and_b32 v136, v20, v240
    v_and_b32 v137, v20, v241
    v_mfma_f32_16x16x32_bf16 v[28:31], v[168:171], v[132:135], v[28:31]
    v_and_b32 v138, v20, v242
    v_and_b32 v139, v20, v243
    v_mfma_f32_16x16x32_bf16 v[32:35], v[172:175], v[132:135], v[32:35]
    s_waitcnt vmcnt(10)
    v_and_b32 v140, v21, v240
    v_and_b32 v141, v21, v241
    v_mfma_f32_16x16x32_bf16 v[28:31], v[176:179], v[136:139], v[28:31]
    v_and_b32 v142, v21, v242
    v_and_b32 v143, v21, v243
    v_mfma_f32_16x16x32_bf16 v[32:35], v[180:183], v[136:139], v[32:35]
    s_waitcnt lgkmcnt(0)
    s_waitcnt vmcnt(8)
    v_and_b32 v144, v22, v240
    v_and_b32 v145, v22, v241
    v_mfma_f32_16x16x32_bf16 v[28:31], v[184:187], v[140:143], v[28:31]
    v_and_b32 v146, v22, v242
    v_and_b32 v147, v22, v243
    v_mfma_f32_16x16x32_bf16 v[32:35], v[188:191], v[140:143], v[32:35]
    s_waitcnt vmcnt(6)
    v_and_b32 v148, v23, v240
    v_and_b32 v149, v23, v241
    v_mfma_f32_16x16x32_bf16 v[28:31], v[192:195], v[144:147], v[28:31]
    v_and_b32 v150, v23, v242
    v_and_b32 v151, v23, v243
    v_mfma_f32_16x16x32_bf16 v[32:35], v[196:199], v[144:147], v[32:35]
    s_waitcnt vmcnt(4)
    v_and_b32 v152, v24, v240
    v_and_b32 v153, v24, v241
    v_mfma_f32_16x16x32_bf16 v[28:31], v[200:203], v[148:151], v[28:31]
    v_and_b32 v154, v24, v242
    v_and_b32 v155, v24, v243
    v_mfma_f32_16x16x32_bf16 v[32:35], v[204:207], v[148:151], v[32:35]
    s_waitcnt vmcnt(2)
    v_and_b32 v156, v25, v240
    v_and_b32 v157, v25, v241
    v_mfma_f32_16x16x32_bf16 v[28:31], v[208:211], v[152:155], v[28:31]
    v_and_b32 v158, v25, v242
    v_and_b32 v159, v25, v243
    v_mfma_f32_16x16x32_bf16 v[32:35], v[212:215], v[152:155], v[32:35]
    s_waitcnt vmcnt(0)
    v_mfma_f32_16x16x32_bf16 v[28:31], v[216:219], v[156:159], v[28:31]
    v_mfma_f32_16x16x32_bf16 v[32:35], v[220:223], v[156:159], v[32:35]
    s_mov_b32 s64, 0
    s_mov_b32 s65, 1085800448
    s_mov_b32 s66, 0x31800000
    s_mov_b32 s67, 0x44000000
    s_nop 3
    v_add_f32_dpp v44, v32, v28 row_ror:8 row_mask:0xf bank_mask:0x3
    v_add_f32_dpp v45, v33, v29 row_ror:8 row_mask:0xf bank_mask:0x3
    s_nop 0
    v_add_f32_dpp v44, v30, v34 row_ror:8 row_mask:0xf bank_mask:0xc
    v_add_f32_dpp v45, v31, v35 row_ror:8 row_mask:0xf bank_mask:0xc
    v_cvt_f64_f32 v[64:65], v44
    v_add_f32 v46, abs(v44), abs(v45)
    v_cvt_f64_f32 v[66:67], v45
    v_cmp_ngt_f32 vcc, 4.0, v46
    v_cmp_lt_f32 s[70:71], s66, v46
L_at2:
    v_add_f64 v[68:69], v[64:65], s[64:65]
    v_add_f64 v[70:71], v[66:67], s[64:65]
    s_cbranch_vccnz L_bad
    s_cmp_eq_u64 s[70:71], 0
    s_cbranch_scc1 L_bad
    buffer_atomic_add_x2 v[68:69], v248, s[80:83], s60 offen sc0
    buffer_atomic_add_x2 v[70:71], v248, s[80:83], s18 offen sc0
    v_add_f64 v[64:65], v[64:65], s[64:65]
    v_add_f64 v[66:67], v[66:67], s[64:65]
    v_mov_b32 v60, s94
    v_mov_b32 v61, s95
    s_waitcnt vmcnt(0)
    v_lshl_add_u64 v[64:65], v[64:65], 0, v[68:69]
    v_lshl_add_u64 v[66:67], v[66:67], 0, v[70:71]
    v_add_f64 v[68:69], v[64:65], -s[64:65]
    v_add_f64 v[70:71], v[66:67], -s[64:65]
    v_cvt_f32_f64 v44, v[68:69]
    v_cvt_f32_f64 v45, v[70:71]
    v_cmp_gt_f32 s[68:69], s67, abs(v44)
    v_cmp_gt_f32 s[70:71], s67, abs(v45)
    v_cvt_pk_bf16_f32 v48, v44, v45
    s_mov_b64 exec, s[68:69]
    buffer_store_short v48, v253, s[84:87], s9 offen
    s_mov_b64 exec, s[70:71]
    buffer_store_short_d16_hi v48, v253, s[84:87], s9 offen offset:16
    s_mov_b32 s63, 0x40000000
    s_mov_b32 s66, 17039360
    s_mov_b64 exec, -1
    v_cmpx_gt_u32 vcc, s63, v253
    v_add_u32 v46, 3209297920, v65
    v_add_u32 v47, 3209297920, v67
    v_cmp_gt_u32 vcc, s66, v46
    v_cmp_gt_u32 s[74:75], s66, v47
    s_andn2_b64 s[68:69], vcc, s[68:69]
    s_andn2_b64 s[70:71], s[74:75], s[70:71]
    s_cmp_lg_u32 s9, 0
    s_cbranch_scc1 L_noep
    s_mov_b64 exec, vcc
    buffer_store_dwordx2 v[60:61], v254, s[80:83], 0 offen offset:0
L_noep:
    s_or_b64 exec, s[68:69], s[70:71]
    s_cbranch_scc1 L_slow2
L_fin:
    s_endpgm
L_bad:
    s_lshl_b32 s63, s29, 1
    s_add_u32 s63, s63, s5
    s_lshl_b32 s63, s63, 8
    s_add_u32 s63, s63, s3
    s_lshl_b32 s63, s63, 10
    s_add_u32 s63, s63, 3276800
    s_lshl_b32 s7, s26, 12
    s_add_u32 s63, s63, s7
    v_mov_b32 v46, v44
    v_mov_b32 v47, v45
    v_bfi_b32 v44, v251, s56, v44
    v_bfi_b32 v45, v251, s57, v45
    v_bfi_b32 v46, v251, s58, v46
    v_bfi_b32 v47, v251, s59, v47
    buffer_store_dwordx4 v[44:47], v2, s[80:83], s63 offen sc1
    v_mov_b32 v64, 0
    v_mov_b32 v65, 0x40900000
    v_mov_b32 v66, 0
    v_mov_b32 v67, v65
    s_mov_b64 vcc, 0
    s_mov_b64 s[70:71], -1
    s_waitcnt vmcnt(0)
    s_branch L_at2
L_slow2:
    v_and_b32 v46, 4294705152, v46
    v_sub_u32 v65, v65, v46
    v_add_f64 v[68:69], v[64:65], -s[64:65]
    v_and_b32 v47, 4294705152, v47
    v_sub_u32 v67, v67, v47
    v_add_f64 v[70:71], v[66:67], -s[64:65]
    v_cndmask_b32 v46, v47, v46, s[68:69]
    v_lshrrev_b32 v46, 18, v46
    s_mov_b64 s[74:75], exec
L_s2a:
    s_lshl_b32 s63, s29, 1
    s_add_u32 s63, s63, s5
    s_lshl_b32 s63, s63, 8
    s_add_u32 s63, s63, s3
    s_lshl_b32 s63, s63, 10
    s_add_u32 s63, s63, 3276800
    v_cvt_f32_f64 v44, v[68:69]
    v_cvt_f32_f64 v45, v[70:71]
    v_mov_b32 v47, 0
    s_mov_b32 s7, 64
L_s2b:
    buffer_load_dwordx4 v[224:227], v2, s[80:83], s63 offen sc1
    s_add_u32 s63, s63, 4096
    s_waitcnt vmcnt(0)
    v_xor_b32 v224, s56, v224
    v_xor_b32 v225, s57, v225
    v_xor_b32 v226, s58, v226
    v_xor_b32 v227, s59, v227
    v_or3_b32 v48, v224, v225, v226
    v_or_b32 v48, v48, v227
    v_and_b32 v48, v251, v48
    v_cmp_ne_u32 vcc, 0, v48
    s_nop 0
    s_andn2_b64 exec, exec, vcc
    v_add_f32 v44, v44, v224
    v_add_f32 v45, v45, v225
    v_add_u32 v47, 1, v47
    s_mov_b64 exec, s[74:75]
    s_sub_u32 s7, s7, 1
    s_cmp_lg_u32 s7, 0
    s_cbranch_scc1 L_s2b
    v_cmp_ne_u32 vcc, v46, v47
    s_sub_u32 s61, s61, 64
    s_cmp_le_i32 s61, 0
    s_cbranch_scc1 L_s2c
    s_cbranch_vccnz L_s2a
L_s2c:
    v_cvt_pk_bf16_f32 v48, v44, v45
    s_mov_b64 exec, s[68:69]
    buffer_store_short v48, v253, s[84:87], s9 offen
    s_mov_b64 exec, s[70:71]
    buffer_store_short_d16_hi v48, v253, s[84:87], s9 offen offset:16
    s_mov_b64 exec, -1
    s_branch L_fin
L_last:
    s_endpgm
.section .rodata,"a"
.p2align 6
.amdhsa_kernel concat_heads__mha_block_cached__mha_block_cached__decode_kernel
  .amdhsa_next_free_vgpr 256
  .amdhsa_next_free_sgpr 102
  .amdhsa_accum_offset 256
  .amdhsa_group_segment_fixed_size 0
  .amdhsa_kernarg_size 104
  .amdhsa_user_sgpr_count 2
  .amdhsa_user_sgpr_kernarg_segment_ptr 1
  .amdhsa_system_sgpr_workgroup_id_x 1
.end_amdhsa_kernel
```
